```python
import torch

def _softmax(x, axis=-1):
    return torch.softmax(x, dim=axis)
def _gelu(x):
    return torch.nn.functional.gelu(x, approximate="tanh")
def _silu(x):
    return torch.nn.functional.silu(x)
def _sigmoid(x):
    return torch.sigmoid(x)
def _layernorm(x, axis=-1, eps=1e-5):
    m = x.mean(dim=axis, keepdim=True)
    v = x.var(dim=axis, keepdim=True, unbiased=False)
    return (x - m) / torch.sqrt(v + eps)
def _scatter_add(tgt, idx, src, axis=0):
    return tgt.clone().index_add_(axis, idx, src)
def _segment_sum(src, seg, n):
    out = torch.zeros((n,) + src.shape[1:], dtype=src.dtype)
    return out.index_add_(0, seg, src)
def _pad(x, pw):
    flat = tuple(v for pair in reversed(pw) for v in pair)
    return torch.nn.functional.pad(x, flat)

kernel_name = 'recurrent_scan__sliding_block__glu_gated_bilinear__prompt'

def setup_inputs():

    _w = (lambda a: (lambda t: t.to(torch.bfloat16) if t.is_floating_point() else t)(torch.as_tensor(a)))
    def _A_setup():
        B, S, D = 1, 2048, 512
        return {
            "x": _w((lambda *s: torch.randn(*s, dtype=torch.bfloat16) * 0.05)(B, S, D)),
            "wqkv": _w((lambda *s: torch.randn(*s, dtype=torch.bfloat16) * 0.2)(D, 3 * D)),
            "wo": _w((lambda *s: torch.randn(*s, dtype=torch.bfloat16) * 0.2)(D, D)),
        }
    _A_in = _A_setup()

    def _B_setup():
        B, S, D, F = 1, 2048, 512, 1792
        return {
            "x": _w((lambda *s: torch.randn(*s, dtype=torch.bfloat16) * 0.05)(B, S, D)),
            "w_gate": _w((lambda *s: torch.randn(*s, dtype=torch.bfloat16) * 0.1)(D, F) * (D ** -0.5)),
            "w_up": _w((lambda *s: torch.randn(*s, dtype=torch.bfloat16) * 0.1)(D, F) * (D ** -0.5)),
            "w_down": _w((lambda *s: torch.randn(*s, dtype=torch.bfloat16) * 0.1)(F, D) * (F ** -0.5)),
        }
    _B_in = _B_setup()

    return {
        "A_x": _A_in["x"],
        "A_wqkv": _A_in["wqkv"],
        "A_wo": _A_in["wo"],
        "B_x": _B_in["x"],
        "B_w_gate": _B_in["w_gate"],
        "B_w_up": _B_in["w_up"],
        "B_w_down": _B_in["w_down"],
    }

def reference(A_x, A_wqkv, A_wo, B_x, B_w_gate, B_w_up, B_w_down):
    def _A_ref(x, wqkv, wo):
        B, S, D = x.shape
        H = 32; Dh = D // H; W = 256
        qkv = (lambda x, *d: x.permute(*d))((x @ wqkv).reshape(B, S, 3, H, Dh), 2, 0, 3, 1, 4)
        q, k, v = qkv[0], qkv[1], qkv[2]
        scores = torch.einsum("bhqd,bhkd->bhqk", q, k) * (Dh ** -0.5)
        idx = torch.arange(S)
        mask = (idx[:, None] - idx[None, :] >= 0) & (idx[:, None] - idx[None, :] < W)
        scores = torch.where(mask[None, None], scores, -1e9)
        p = _softmax(scores, axis=-1)
        o = torch.einsum("bhqk,bhkd->bhqd", p, v)
        return (lambda x, *d: x.permute(*d))(o, 0, 2, 1, 3).reshape(B, S, D) @ wo

    def _B_ref(x, w_gate, w_up, w_down):
        g = torch.einsum("bsd,df->bsf", x, w_gate)
        u = torch.einsum("bsd,df->bsf", x, w_up)
        h = g * u
        return torch.einsum("bsf,fd->bsd", h, w_down)

    x = A_x
    xn = _layernorm(x, axis=-1)
    s = _A_ref(xn, A_wqkv, A_wo)
    g = _silu(_B_ref(xn, B_w_gate, B_w_up, B_w_down))
    return x + s * g
```

```asm
; @launch grid=(256,1,1) block=(256,1,1) lds=163840
.amdgcn_target "amdgcn-amd-amdhsa--gfx950"
.text
.globl recurrent_scan__sliding_block__glu_gated_bilinear__prompt_kernel
.p2align 8
.type recurrent_scan__sliding_block__glu_gated_bilinear__prompt_kernel,@function
recurrent_scan__sliding_block__glu_gated_bilinear__prompt_kernel:
    s_cmpk_ge_u32 s2, 256
    s_cbranch_scc1 L_end
    s_load_dwordx4 s[4:7], s[0:1], 0
    s_load_dwordx4 s[20:23], s[0:1], 32
    s_load_dwordx2 s[28:29], s[0:1], 72
    s_getpc_b64 s[84:85]
L_pc:
    s_andn2_b32 s82, s2, 7
    v_lshlrev_b32 v148, 3, v0
    v_lshl_add_u32 v148, s82, 8, v148
    v_min_u32 v148, L_last-L_pc-4, v148
    global_load_dword v154, v148, s[84:85]
    s_and_b32 s87, s2, 1
    s_lshl_b32 s87, s87, 8
    s_add_u32 s87, s87, s82
    v_lshrrev_b32 v149, 5, v0
    v_add_u32 v149, s87, v149
    v_and_b32 v150, 31, v0
    s_bfe_u32 s83, s2, 0x20001
    s_mul_i32 s83, s83, 3
    v_add_lshl_u32 v150, v150, s83, 7
    s_movk_i32 s86, 3072
    v_mad_u32_u24 v150, v149, s86, v150
    v_lshl_add_u32 v149, v149, 9, v150
    s_lshr_b32 s83, s87, 6
    v_lshrrev_b32 v151, 3, v0
    v_lshl_add_u32 v151, s87, 2, v151
    v_add_u32 v152, s83, v0
    v_and_b32 v152, 7, v152
    v_lshlrev_b32 v152, 7, v152
    v_lshl_add_u32 v151, v151, 10, v152
    s_mov_b32 exec_lo, 0x1010101
    s_mov_b32 exec_hi, exec_lo
    s_waitcnt lgkmcnt(0)
    global_load_dword v154, v151, s[4:5]
    s_mov_b32 exec_lo, 7
    s_mov_b32 exec_hi, exec_lo
    global_load_dword v154, v150, s[6:7]
    global_load_dword v154, v150, s[6:7] offset:1536
    global_load_dword v154, v149, s[20:21]
    global_load_dword v154, v149, s[22:23]
    s_mov_b64 exec, -1
    s_mov_b64 s[8:9], s[6:7]
    s_mov_b64 s[24:25], s[22:23]
    s_load_dwordx2 s[36:37], s[0:1], 16
    s_load_dwordx2 s[32:33], s[0:1], 48
    s_load_dwordx2 s[40:41], s[0:1], 56
    s_mov_b32 s38, 0x80000
    s_mov_b32 s39, 0x20000
    s_mov_b32 s34, 0x1c0000
    s_mov_b32 s35, 0x20000
    s_mov_b32 s42, 0x200000
    s_mov_b32 s43, 0x20000
    v_lshrrev_b32 v2, 6, v0
    v_and_b32 v0, 63, v0
    v_readfirstlane_b32 s48, v2
    v_lshlrev_b32 v1, 4, v0
    s_and_b32 s62, s2, 7
    s_lshr_b32 s63, s2, 3
    s_and_b32 s51, s62, 1
    s_lshl_b32 s51, s51, 3
    s_and_b32 s64, s63, 7
    s_add_u32 s51, s51, s64
    s_lshr_b32 s62, s62, 1
    s_lshr_b32 s63, s63, 3
    s_lshl2_add_u32 s52, s62, s63
    s_and_b32 s49, s48, 1
    s_lshr_b32 s50, s48, 1
    s_lshl_b32 s79, s48, 12
    s_lshl_b32 s80, s48, 11
    s_mov_b32 s6, 0x200000
    s_mov_b32 s7, 0x20000
    s_mov_b32 s30, 0x1000000
    s_mov_b32 s31, 0x20000
    s_mov_b32 s10, 0x180000
    s_mov_b32 s11, 0x20000
    s_mov_b32 s22, 0x1c0000
    s_mov_b32 s23, 0x20000
    s_mov_b32 s26, 0x1c0000
    s_mov_b32 s27, 0x20000
    s_mov_b32 s15, 0x20000
    s_mov_b32 s19, 0x20000
    s_lshl_b32 s64, s51, 4
    s_add_u32 s64, s64, s52
    s_lshl2_add_u32 s64, s64, s48
    s_lshl_b32 s65, s64, 11
    s_lshl_b32 s64, s64, 5
    s_add_u32 s44, s64, 65536
    s_mul_i32 s66, s62, 3
    s_add_u32 s67, s66, s63
    s_add_u32 s66, s66, 12
    s_cmp_eq_u32 s63, 3
    s_cselect_b32 s53, 1, 0
    s_cselect_b32 s68, s66, s67
    s_mov_b32 s54, 196608
    s_cselect_b32 s54, s54, 229376
    s_lshl_b32 s14, s54, 3
    s_mov_b32 s18, s14
    s_lshl_b32 s69, s68, 7
    s_add_u32 s70, s69, 128
    s_add_u32 s71, s69, 256
    s_cmp_eq_u32 s53, 1
    s_cselect_b32 s70, s70, s69
    s_cselect_b32 s71, s71, s69
    s_mov_b32 s74, s67
    s_lshr_b32 s55, s51, 1
    v_lshrrev_b32 v2, 3, v0
    v_and_b32 v3, 7, v0
    v_lshrrev_b32 v4, 4, v0
    v_xor_b32 v5, v3, v4
    v_lshlrev_b32 v5, 4, v5
    v_lshl_add_u32 v5, v2, 10, v5
    s_lshl_b32 s62, s51, 17
    s_lshl_b32 s63, s48, 15
    s_add_u32 s62, s62, s63
    v_add_u32 v10, s62, v5
    v_xor_b32 v11, 64, v10
    v_add_u32 v12, 14336, v10
    v_add_u32 v13, 21504, v11
    v_add_u32 v11, 7168, v11
    v_and_b32 v4, 1, v4
    v_lshlrev_b32 v4, 2, v4
    v_xor_b32 v3, v3, v4
    v_lshlrev_b32 v3, 4, v3
    s_lshl_b32 s62, s48, 4
    v_add_u32 v2, s62, v2
    s_lshr_b32 s63, s54, 6
    v_mul_u32_u24 v4, 3072, v2
    v_mul_u32_u24 v5, s63, v2
    v_add3_u32 v14, v4, v3, s69
    v_add3_u32 v16, v5, v3, s70
    v_add3_u32 v18, v5, v3, s71
    s_lshr_b32 s63, s54, 3
    s_sub_u32 s63, s63, 1024
    v_mov_b32 v137, 0
    s_movk_i32 s64, 23552
    v_xad_u32 v17, v16, 16, s63
    v_xad_u32 v19, v18, 16, s63
    v_xad_u32 v15, v14, 16, s64
    s_waitcnt lgkmcnt(0)
    s_cmp_eq_u32 s53, 1
    s_cselect_b32 s12, s8, s20
    s_cselect_b32 s13, s9, s21
    s_cselect_b32 s16, s8, s24
    s_cselect_b32 s17, s9, s25
    s_lshl_b32 s56, s55, 7
    s_mul_i32 s57, s55, 196608
    s_mul_i32 s58, s55, s54
    s_add_u32 m0, s79, 24576
    s_nop 0
    buffer_load_dwordx4 v10, s[4:7], s56 offen offset:0 lds
    buffer_load_dwordx4 v11, s[4:7], s56 offen offset:1024 lds
    buffer_load_dwordx4 v12, s[4:7], s56 offen offset:2048 lds
    buffer_load_dwordx4 v13, s[4:7], s56 offen offset:3072 lds
    s_add_u32 m0, s80, 0
    s_nop 0
    buffer_load_dwordx4 v14, s[8:11], s57 offen offset:0 lds
    buffer_load_dwordx4 v15, s[8:11], s57 offen offset:1024 lds
    s_add_u32 m0, s80, 8192
    s_nop 0
    buffer_load_dwordx4 v16, s[12:15], s58 offen offset:0 lds
    buffer_load_dwordx4 v17, s[12:15], s58 offen offset:1024 lds
    s_add_u32 m0, s80, 16384
    s_nop 0
    buffer_load_dwordx4 v18, s[16:19], s58 offen offset:0 lds
    buffer_load_dwordx4 v19, s[16:19], s58 offen offset:1024 lds
    s_lshr_b32 s82, s2, 6
    s_lshl2_add_u32 s82, s82, s48
    s_lshl_b32 s82, s82, 3
    s_lshl_b32 s83, s51, 7
    s_add_u32 s82, s82, s83
    v_and_b32 v154, 7, v0
    v_lshrrev_b32 v155, 3, v0
    v_add_u32 v154, s82, v154
    s_lshr_b32 s83, s51, 1
    s_add_u32 s83, s83, 2
    v_add_u32 v155, s83, v155
    v_and_b32 v155, 7, v155
    v_lshlrev_b32 v154, 10, v154
    v_lshl_add_u32 v148, v155, 7, v154
    v_cmp_gt_u32 vcc, 48, v0
    v_mov_b32 v153, 0x40000000
    s_and_b32 s82, s51, 7
    v_cndmask_b32 v148, v153, v148, vcc
    s_lshl2_add_u32 s82, s82, s48
    s_lshr_b32 s83, s51, 3
    s_lshl_b32 s83, s83, 8
    s_add_u32 s83, s83, 320
    v_mad_u32_u24 v154, s82, 6, v0
    v_add_u32 v154, s83, v154
    v_and_b32 v154, 511, v154
    s_lshr_b32 s83, s54, 6
    v_mul_u32_u24 v149, 3072, v154
    v_mul_u32_u24 v150, s83, v154
    v_lshl_add_u32 v154, s82, 4, v0
    v_mul_u32_u24 v152, 3584, v154
    v_cmp_gt_u32 vcc, 6, v0
    v_add_u32 v149, s69, v149
    v_add_u32 v151, s71, v150
    v_add_u32 v150, s70, v150
    s_add_u32 s82, s52, 12
    s_lshl_b32 s82, s82, 7
    v_add_u32 v152, s82, v152
    v_cndmask_b32 v149, v153, v149, vcc
    v_cndmask_b32 v150, v153, v150, vcc
    v_cndmask_b32 v151, v153, v151, vcc
    v_cmp_gt_u32 vcc, 16, v0
    s_nop 0
    s_nop 0
    v_cndmask_b32 v152, v153, v152, vcc
    s_add_u32 s62, s52, 12
    s_lshl_b32 s62, s62, 7
    v_mul_u32_u24 v5, 3584, v2
    v_add3_u32 v20, v5, v3, s62
    s_movk_i32 s64, 27648
    v_xad_u32 v21, v20, 16, s64
    v_and_b32 v2, 15, v0
    s_lshl_b32 s62, s49, 6
    v_add_u32 v2, s62, v2
    v_lshrrev_b32 v3, 4, v0
    v_bfe_u32 v4, v0, 1, 3
    v_xor_b32 v4, v4, v3
    s_lshl_b32 s62, s49, 2
    v_xor_b32 v4, s62, v4
    v_lshlrev_b32 v4, 4, v4
    v_lshl_add_u32 v22, v2, 7, v4
    v_add_u32 v22, 24576, v22
    v_xor_b32 v23, 64, v22
    v_add_u32 v156, 81920, v22
    v_add_u32 v157, 81920, v23
    v_bfe_u32 v2, v0, 2, 2
    v_lshl_add_u32 v2, v3, 3, v2
    v_bfe_u32 v4, v0, 4, 1
    v_and_b32 v5, 2, v0
    v_add_u32 v5, v4, v5
    v_bfe_u32 v6, v0, 3, 1
    v_xor_b32 v6, s50, v6
    v_lshl_add_u32 v5, v6, 2, v5
    v_and_b32 v6, 1, v0
    v_lshlrev_b32 v6, 3, v6
    v_lshl_add_u32 v5, v5, 4, v6
    v_lshl_add_u32 v5, v2, 7, v5
    s_lshl_b32 s62, s49, 12
    s_sub_u32 s63, 4096, s62
    v_add_u32 v26, s62, v5
    v_add_u32 v28, s63, v5
    v_xor_b32 v27, 16, v26
    v_xor_b32 v29, 16, v28
    v_add_u32 v138, 81920, v26
    v_add_u32 v139, 81920, v27
    v_add_u32 v140, 81920, v28
    v_add_u32 v141, 81920, v29
    v_and_b32 v2, 0xf0, v1
    v_lshrrev_b32 v3, 5, v0
    v_lshl_add_u32 v5, v4, 9, v2
    v_lshlrev_b32 v2, 1, v2
    v_lshl_add_u32 v31, v3, 10, v5
    v_lshl_add_u32 v2, v4, 4, v2
    v_lshl_add_u32 v30, v3, 16, v5
    v_lshl_add_u32 v34, v3, 16, v2
    s_lshl_b32 s62, s50, 8
    s_add_u32 s62, s62, 114688
    s_lshl_b32 s63, s49, 7
    s_add_u32 s63, s63, s62
    v_lshrrev_b32 v2, 4, v0
    v_lshlrev_b32 v2, 3, v2
    v_lshl_add_u32 v2, v6, 2, v2
    v_add_u32 v2, s63, v2
    v_lshlrev_b32 v7, 3, v0
    v_add_u32 v7, 118784, v7
    v_and_b32 v8, 14, v0
    v_cmp_eq_u32 vcc, 0, v8
    v_bfe_u32 v8, v0, 2, 2
    v_and_b32 v9, 3, v0
    v_cndmask_b32 v32, v7, v2, vcc
    v_lshlrev_b32 v9, 3, v9
    v_lshl_add_u32 v9, v4, 5, v9
    v_lshl_add_u32 v9, v8, 6, v9
    v_add_u32 v33, s62, v9
    s_mov_b32 s82, 0x00010001
    s_mov_b32 s83, s82
    v_mov_b32 v2, 0x3f803f80
    v_cndmask_b32 v36, 0, v2, s[82:83]
    v_cndmask_b32 v37, 0, v2, s[82:83]
    v_cndmask_b32 v38, 0, v2, s[82:83]
    v_cndmask_b32 v39, 0, v2, s[82:83]
    s_lshl_b64 s[82:83], s[82:83], 1
    v_cndmask_b32 v40, 0, v2, s[82:83]
    v_cndmask_b32 v41, 0, v2, s[82:83]
    v_cndmask_b32 v42, 0, v2, s[82:83]
    v_cndmask_b32 v43, 0, v2, s[82:83]
    s_lshl_b32 s62, s51, 1
    s_add_u32 s62, s62, s49
    s_lshl_b32 s63, s62, 11
    s_lshl_b32 s64, s68, 1
    s_add_u32 s64, s64, s50
    s_lshl_b32 s64, s64, 17
    s_add_u32 s63, s63, s64
    s_cmp_lt_u32 s68, 8
    s_cselect_b32 s78, 0x3eb8aa3b, 1.0
    s_mov_b32 s67, s68
    s_add_u32 s68, s63, 1048576
    s_add_u32 s70, s68, 0x40000
    s_add_u32 s72, s68, 0x80000
    s_mul_i32 s63, s62, 229376
    s_lshl_b32 s64, s50, 11
    s_add_u32 s63, s63, s64
    s_add_u32 s63, s63, 9437184
    s_lshl_b32 s74, s74, 12
    s_add_u32 s74, s74, s63
    s_add_u32 s75, s74, 114688
    s_add_u32 s64, s52, 12
    s_lshl_b32 s64, s64, 12
    s_add_u32 s76, s64, s63
    s_add_u32 s77, s76, 114688
    s_lshl_b32 s62, s62, 10
    s_add_u32 s66, s62, 65536
    s_cmp_ge_u32 s67, 16
    s_movk_i32 s62, 256
    s_cmovk_i32 s62, 512
    s_add_u32 s69, s68, s62
    s_cmp_ge_u32 s67, 15
    s_movk_i32 s62, 256
    s_cmovk_i32 s62, 512
    s_add_u32 s71, s70, s62
    s_cmp_ge_u32 s67, 14
    s_movk_i32 s62, 256
    s_cmovk_i32 s62, 512
    s_add_u32 s73, s72, s62
    s_add_u32 s55, s55, 1
    s_and_b32 s55, s55, 7
    s_lshl_b32 s56, s55, 7
    s_mul_i32 s57, s55, 196608
    s_mul_i32 s58, s55, s54
    s_add_u32 m0, s79, 65536
    s_nop 0
    buffer_load_dwordx4 v10, s[4:7], s56 offen offset:0 lds
    buffer_load_dwordx4 v11, s[4:7], s56 offen offset:1024 lds
    buffer_load_dwordx4 v12, s[4:7], s56 offen offset:2048 lds
    buffer_load_dwordx4 v13, s[4:7], s56 offen offset:3072 lds
    s_add_u32 m0, s80, 40960
    s_nop 0
    buffer_load_dwordx4 v14, s[8:11], s57 offen offset:0 lds
    buffer_load_dwordx4 v15, s[8:11], s57 offen offset:1024 lds
    s_add_u32 m0, s80, 49152
    s_nop 0
    buffer_load_dwordx4 v16, s[12:15], s58 offen offset:0 lds
    buffer_load_dwordx4 v17, s[12:15], s58 offen offset:1024 lds
    s_add_u32 m0, s80, 57344
    s_nop 0
    buffer_load_dwordx4 v18, s[16:19], s58 offen offset:0 lds
    buffer_load_dwordx4 v19, s[16:19], s58 offen offset:1024 lds
    s_mov_b32 s81, 0x20000
    s_waitcnt vmcnt(10)
    s_barrier
    ds_read_b128 a[0:3], v22 offset:0
    ds_read_b128 a[4:7], v22 offset:2048
    ds_read_b128 a[8:11], v22 offset:4096
    ds_read_b128 a[12:15], v22 offset:6144
    ds_read_b64_tr_b16 v[72:73], v26 offset:0
    ds_read_b64_tr_b16 v[74:75], v26 offset:512
    ds_read_b64_tr_b16 v[76:77], v26 offset:8192
    ds_read_b64_tr_b16 v[78:79], v26 offset:8704
    ds_read_b64_tr_b16 v[80:81], v26 offset:16384
    ds_read_b64_tr_b16 v[82:83], v26 offset:16896
    s_waitcnt lgkmcnt(4)
    v_mfma_f32_16x16x32_bf16 v[160:163], v[72:75], a[0:3], 0
    ds_read_b64_tr_b16 v[84:85], v27 offset:0
    buffer_load_dword v136, v137, s[28:31], 0 offen sc1
    v_mfma_f32_16x16x32_bf16 v[168:171], v[72:75], a[4:7], 0
    ds_read_b64_tr_b16 v[86:87], v27 offset:512
    buffer_load_dwordx4 v[96:99], v1, s[4:7], s65 offen offset:0
    v_mfma_f32_16x16x32_bf16 v[176:179], v[72:75], a[8:11], 0
    ds_read_b64_tr_b16 v[88:89], v27 offset:8192
    v_mfma_f32_16x16x32_bf16 v[184:187], v[72:75], a[12:15], 0
    ds_read_b64_tr_b16 v[90:91], v27 offset:8704
    v_mfma_f32_16x16x32_bf16 v[44:47], v[72:75], v[36:39], 0
    ds_read_b64_tr_b16 v[92:93], v27 offset:16384
    s_waitcnt lgkmcnt(7)
    v_mfma_f32_16x16x32_bf16 v[192:195], v[76:79], a[0:3], 0
    ds_read_b64_tr_b16 v[94:95], v27 offset:16896
    buffer_load_dwordx4 v[100:103], v1, s[4:7], s65 offen offset:1024
    v_mfma_f32_16x16x32_bf16 v[200:203], v[76:79], a[4:7], 0
    s_add_u32 s55, s55, 1
    s_and_b32 s55, s55, 7
    v_mfma_f32_16x16x32_bf16 v[208:211], v[76:79], a[8:11], 0
    s_lshl_b32 s56, s55, 7
    s_mul_i32 s57, s55, 196608
    v_mfma_f32_16x16x32_bf16 v[216:219], v[76:79], a[12:15], 0
    s_mul_i32 s58, s55, s54
    s_add_u32 m0, s79, 106496
    v_mfma_f32_16x16x32_bf16 v[48:51], v[76:79], v[36:39], 0
    s_waitcnt lgkmcnt(6)
    v_mfma_f32_16x16x32_bf16 v[224:227], v[80:83], a[0:3], 0
    buffer_load_dwordx4 v10, s[4:7], s56 offen offset:0 lds
    v_mfma_f32_16x16x32_bf16 v[232:235], v[80:83], a[4:7], 0
    v_mfma_f32_16x16x32_bf16 v[240:243], v[80:83], a[8:11], 0
    v_mfma_f32_16x16x32_bf16 v[248:251], v[80:83], a[12:15], 0
    v_mfma_f32_16x16x32_bf16 v[52:55], v[80:83], v[36:39], 0
    buffer_load_dwordx4 v11, s[4:7], s56 offen offset:1024 lds
    s_waitcnt lgkmcnt(4)
    v_mfma_f32_16x16x32_bf16 v[164:167], v[84:87], a[0:3], 0
    ds_read_b64_tr_b16 v[72:73], v28 offset:0
    v_mfma_f32_16x16x32_bf16 v[172:175], v[84:87], a[4:7], 0
    ds_read_b64_tr_b16 v[74:75], v28 offset:512
    v_mfma_f32_16x16x32_bf16 v[180:183], v[84:87], a[8:11], 0
    ds_read_b128 a[16:19], v23 offset:0
    v_mfma_f32_16x16x32_bf16 v[188:191], v[84:87], a[12:15], 0
    ds_read_b128 a[20:23], v23 offset:2048
    buffer_load_dwordx4 v12, s[4:7], s56 offen offset:2048 lds
    v_mfma_f32_16x16x32_bf16 v[44:47], v[84:87], v[40:43], v[44:47]
    ds_read_b128 a[24:27], v23 offset:4096
    s_waitcnt lgkmcnt(7)
    v_mfma_f32_16x16x32_bf16 v[196:199], v[88:91], a[0:3], 0
    ds_read_b128 a[28:31], v23 offset:6144
    v_mfma_f32_16x16x32_bf16 v[204:207], v[88:91], a[4:7], 0
    ds_read_b64_tr_b16 v[76:77], v28 offset:8192
    v_mfma_f32_16x16x32_bf16 v[212:215], v[88:91], a[8:11], 0
    ds_read_b64_tr_b16 v[78:79], v28 offset:8704
    v_mfma_f32_16x16x32_bf16 v[220:223], v[88:91], a[12:15], 0
    ds_read_b64_tr_b16 v[80:81], v28 offset:16384
    buffer_load_dwordx4 v13, s[4:7], s56 offen offset:3072 lds
    v_mfma_f32_16x16x32_bf16 v[48:51], v[88:91], v[40:43], v[48:51]
    ds_read_b64_tr_b16 v[82:83], v28 offset:16896
    s_add_u32 m0, s80, 81920
    s_waitcnt lgkmcnt(10)
    v_mfma_f32_16x16x32_bf16 v[228:231], v[92:95], a[0:3], 0
    v_mfma_f32_16x16x32_bf16 v[236:239], v[92:95], a[4:7], 0
    v_mfma_f32_16x16x32_bf16 v[244:247], v[92:95], a[8:11], 0
    v_mfma_f32_16x16x32_bf16 v[252:255], v[92:95], a[12:15], 0
    buffer_load_dwordx4 v14, s[8:11], s57 offen offset:0 lds
    v_mfma_f32_16x16x32_bf16 v[52:55], v[92:95], v[40:43], v[52:55]
    s_waitcnt lgkmcnt(7)
    v_mfma_f32_16x16x32_bf16 v[160:163], v[72:75], a[16:19], v[160:163]
    ds_read_b64_tr_b16 v[84:85], v29 offset:0
    s_waitcnt lgkmcnt(7)
    v_mfma_f32_16x16x32_bf16 v[168:171], v[72:75], a[20:23], v[168:171]
    ds_read_b64_tr_b16 v[86:87], v29 offset:512
    s_waitcnt lgkmcnt(7)
    v_mfma_f32_16x16x32_bf16 v[176:179], v[72:75], a[24:27], v[176:179]
    ds_read_b64_tr_b16 v[88:89], v29 offset:8192
    buffer_load_dwordx4 v15, s[8:11], s57 offen offset:1024 lds
    s_waitcnt lgkmcnt(7)
    v_mfma_f32_16x16x32_bf16 v[184:187], v[72:75], a[28:31], v[184:187]
    ds_read_b64_tr_b16 v[90:91], v29 offset:8704
    s_add_u32 m0, s80, 90112
    s_waitcnt lgkmcnt(6)
    v_mfma_f32_16x16x32_bf16 v[192:195], v[76:79], a[16:19], v[192:195]
    ds_read_b64_tr_b16 v[92:93], v29 offset:16384
    v_mfma_f32_16x16x32_bf16 v[200:203], v[76:79], a[20:23], v[200:203]
    ds_read_b64_tr_b16 v[94:95], v29 offset:16896
    v_mfma_f32_16x16x32_bf16 v[208:211], v[76:79], a[24:27], v[208:211]
    v_mfma_f32_16x16x32_bf16 v[216:219], v[76:79], a[28:31], v[216:219]
    buffer_load_dwordx4 v16, s[12:15], s58 offen offset:0 lds
    s_waitcnt lgkmcnt(6)
    v_mfma_f32_16x16x32_bf16 v[224:227], v[80:83], a[16:19], v[224:227]
    v_mfma_f32_16x16x32_bf16 v[232:235], v[80:83], a[20:23], v[232:235]
    v_mfma_f32_16x16x32_bf16 v[240:243], v[80:83], a[24:27], v[240:243]
    v_mfma_f32_16x16x32_bf16 v[248:251], v[80:83], a[28:31], v[248:251]
    buffer_load_dwordx4 v17, s[12:15], s58 offen offset:1024 lds
    s_add_u32 m0, s80, 98304
    s_waitcnt vmcnt(11) lgkmcnt(0)
    s_barrier
    v_mfma_f32_16x16x32_bf16 v[164:167], v[84:87], a[16:19], v[164:167]
    ds_read_b64_tr_b16 v[72:73], v26 offset:40960
    v_mfma_f32_16x16x32_bf16 v[172:175], v[84:87], a[20:23], v[172:175]
    ds_read_b64_tr_b16 v[74:75], v26 offset:41472
    v_mfma_f32_16x16x32_bf16 v[180:183], v[84:87], a[24:27], v[180:183]
    ds_read_b128 a[32:35], v22 offset:40960
    v_mfma_f32_16x16x32_bf16 v[188:191], v[84:87], a[28:31], v[188:191]
    ds_read_b128 a[36:39], v22 offset:43008
    buffer_load_dwordx4 v18, s[16:19], s58 offen offset:0 lds
    v_mfma_f32_16x16x32_bf16 v[196:199], v[88:91], a[16:19], v[196:199]
    ds_read_b128 a[40:43], v22 offset:45056
    v_mfma_f32_16x16x32_bf16 v[204:207], v[88:91], a[20:23], v[204:207]
    ds_read_b128 a[44:47], v22 offset:47104
    v_mfma_f32_16x16x32_bf16 v[212:215], v[88:91], a[24:27], v[212:215]
    ds_read_b64_tr_b16 v[76:77], v26 offset:49152
    v_mfma_f32_16x16x32_bf16 v[220:223], v[88:91], a[28:31], v[220:223]
    ds_read_b64_tr_b16 v[78:79], v26 offset:49664
    v_mfma_f32_16x16x32_bf16 v[228:231], v[92:95], a[16:19], v[228:231]
    ds_read_b64_tr_b16 v[80:81], v26 offset:57344
    buffer_load_dwordx4 v19, s[16:19], s58 offen offset:1024 lds
    v_mfma_f32_16x16x32_bf16 v[236:239], v[92:95], a[20:23], v[236:239]
    ds_read_b64_tr_b16 v[82:83], v26 offset:57856
    s_add_u32 s55, s55, 1
    v_mfma_f32_16x16x32_bf16 v[244:247], v[92:95], a[24:27], v[244:247]
    s_and_b32 s55, s55, 7
    s_lshl_b32 s56, s55, 7
    v_mfma_f32_16x16x32_bf16 v[252:255], v[92:95], a[28:31], v[252:255]
    s_mul_i32 s57, s55, 196608
    s_mul_i32 s58, s55, s54
    s_waitcnt lgkmcnt(7)
    v_mfma_f32_16x16x32_bf16 v[160:163], v[72:75], a[32:35], v[160:163]
    ds_read_b64_tr_b16 v[84:85], v27 offset:40960
    s_add_u32 m0, s79, 147456
    s_waitcnt lgkmcnt(7)
    v_mfma_f32_16x16x32_bf16 v[168:171], v[72:75], a[36:39], v[168:171]
    ds_read_b64_tr_b16 v[86:87], v27 offset:41472
    buffer_load_dwordx4 v10, s[4:7], s56 offen offset:0 lds
    s_waitcnt lgkmcnt(7)
    v_mfma_f32_16x16x32_bf16 v[176:179], v[72:75], a[40:43], v[176:179]
    ds_read_b64_tr_b16 v[88:89], v27 offset:49152
    s_waitcnt vmcnt(13)
    v_readfirstlane_b32 s60, v136
    s_waitcnt lgkmcnt(7)
    v_mfma_f32_16x16x32_bf16 v[184:187], v[72:75], a[44:47], v[184:187]
    ds_read_b64_tr_b16 v[90:91], v27 offset:49664
    s_add_u32 s60, s60, 1
    v_mfma_f32_16x16x32_bf16 v[44:47], v[72:75], v[36:39], v[44:47]
    ds_read_b64_tr_b16 v[92:93], v27 offset:57344
    s_mul_i32 s61, s60, 0x9e3779b1
    s_waitcnt lgkmcnt(7)
    v_mfma_f32_16x16x32_bf16 v[192:195], v[76:79], a[32:35], v[192:195]
    ds_read_b64_tr_b16 v[94:95], v27 offset:57856
    buffer_load_dwordx4 v11, s[4:7], s56 offen offset:1024 lds
    v_mfma_f32_16x16x32_bf16 v[200:203], v[76:79], a[36:39], v[200:203]
    s_xor_b32 s61, s61, 0x7f4a7c15
    s_waitcnt vmcnt(13)
    v_lshlrev_b32 v104, 16, v96
    v_mfma_f32_16x16x32_bf16 v[208:211], v[76:79], a[40:43], v[208:211]
    v_and_b32 v105, 0xffff0000, v96
    v_lshlrev_b32 v106, 16, v97
    v_mfma_f32_16x16x32_bf16 v[216:219], v[76:79], a[44:47], v[216:219]
    v_and_b32 v107, 0xffff0000, v97
    v_lshlrev_b32 v108, 16, v98
    v_mfma_f32_16x16x32_bf16 v[48:51], v[76:79], v[36:39], v[48:51]
    buffer_load_dwordx4 v12, s[4:7], s56 offen offset:2048 lds
    v_and_b32 v109, 0xffff0000, v98
    s_waitcnt lgkmcnt(6)
    v_mfma_f32_16x16x32_bf16 v[224:227], v[80:83], a[32:35], v[224:227]
    v_lshlrev_b32 v110, 16, v99
    v_and_b32 v111, 0xffff0000, v99
    v_mfma_f32_16x16x32_bf16 v[232:235], v[80:83], a[36:39], v[232:235]
    s_waitcnt vmcnt(13)
    v_lshlrev_b32 v112, 16, v100
    v_and_b32 v113, 0xffff0000, v100
    v_mfma_f32_16x16x32_bf16 v[240:243], v[80:83], a[40:43], v[240:243]
    v_lshlrev_b32 v114, 16, v101
    v_and_b32 v115, 0xffff0000, v101
    v_mfma_f32_16x16x32_bf16 v[248:251], v[80:83], a[44:47], v[248:251]
    v_lshlrev_b32 v116, 16, v102
    v_and_b32 v117, 0xffff0000, v102
    v_mfma_f32_16x16x32_bf16 v[52:55], v[80:83], v[36:39], v[52:55]
    buffer_load_dwordx4 v13, s[4:7], s56 offen offset:3072 lds
    s_add_u32 m0, s80, 122880
    s_waitcnt lgkmcnt(4)
    v_mfma_f32_16x16x32_bf16 v[164:167], v[84:87], a[32:35], v[164:167]
    ds_read_b64_tr_b16 v[72:73], v28 offset:40960
    v_lshlrev_b32 v118, 16, v103
    v_mfma_f32_16x16x32_bf16 v[172:175], v[84:87], a[36:39], v[172:175]
    ds_read_b64_tr_b16 v[74:75], v28 offset:41472
    v_and_b32 v119, 0xffff0000, v103
    v_mfma_f32_16x16x32_bf16 v[180:183], v[84:87], a[40:43], v[180:183]
    ds_read_b128 a[48:51], v23 offset:40960
    v_add_f32 v120, v104, v105
    v_mfma_f32_16x16x32_bf16 v[188:191], v[84:87], a[44:47], v[188:191]
    ds_read_b128 a[52:55], v23 offset:43008
    buffer_load_dwordx4 v14, s[8:11], s57 offen offset:0 lds
    v_mfma_f32_16x16x32_bf16 v[44:47], v[84:87], v[40:43], v[44:47]
    ds_read_b128 a[56:59], v23 offset:45056
    v_add_f32 v121, v112, v113
    s_waitcnt lgkmcnt(7)
    v_mfma_f32_16x16x32_bf16 v[196:199], v[88:91], a[32:35], v[196:199]
    ds_read_b128 a[60:63], v23 offset:47104
    v_add_f32 v120, v120, v106
    v_mfma_f32_16x16x32_bf16 v[204:207], v[88:91], a[36:39], v[204:207]
    ds_read_b64_tr_b16 v[76:77], v28 offset:49152
    v_add_f32 v121, v121, v114
    v_mfma_f32_16x16x32_bf16 v[212:215], v[88:91], a[40:43], v[212:215]
    ds_read_b64_tr_b16 v[78:79], v28 offset:49664
    v_add_f32 v120, v120, v107
    v_mfma_f32_16x16x32_bf16 v[220:223], v[88:91], a[44:47], v[220:223]
    ds_read_b64_tr_b16 v[80:81], v28 offset:57344
    buffer_load_dwordx4 v15, s[8:11], s57 offen offset:1024 lds
    v_mfma_f32_16x16x32_bf16 v[48:51], v[88:91], v[40:43], v[48:51]
    ds_read_b64_tr_b16 v[82:83], v28 offset:57856
    s_add_u32 m0, s80, 131072
    s_waitcnt lgkmcnt(10)
    v_mfma_f32_16x16x32_bf16 v[228:231], v[92:95], a[32:35], v[228:231]
    v_add_f32 v121, v121, v115
    v_add_f32 v120, v120, v108
    v_mfma_f32_16x16x32_bf16 v[236:239], v[92:95], a[36:39], v[236:239]
    v_add_f32 v121, v121, v116
    v_add_f32 v120, v120, v109
    v_mfma_f32_16x16x32_bf16 v[244:247], v[92:95], a[40:43], v[244:247]
    buffer_load_dwordx4 v16, s[12:15], s58 offen offset:0 lds
    v_add_f32 v121, v121, v117
    v_mfma_f32_16x16x32_bf16 v[252:255], v[92:95], a[44:47], v[252:255]
    v_add_f32 v120, v120, v110
    v_add_f32 v121, v121, v118
    v_mfma_f32_16x16x32_bf16 v[52:55], v[92:95], v[40:43], v[52:55]
    v_add_f32 v120, v120, v111
    v_add_f32 v121, v121, v119
    s_waitcnt lgkmcnt(7)
    v_mfma_f32_16x16x32_bf16 v[160:163], v[72:75], a[48:51], v[160:163]
    ds_read_b64_tr_b16 v[84:85], v29 offset:40960
    v_add_f32_dpp v120, v120, v120 quad_perm:[1,0,3,2] row_mask:0xf bank_mask:0xf
    s_waitcnt lgkmcnt(7)
    v_mfma_f32_16x16x32_bf16 v[168:171], v[72:75], a[52:55], v[168:171]
    ds_read_b64_tr_b16 v[86:87], v29 offset:41472
    v_add_f32_dpp v121, v121, v121 quad_perm:[1,0,3,2] row_mask:0xf bank_mask:0xf
    s_waitcnt lgkmcnt(7)
    v_mfma_f32_16x16x32_bf16 v[176:179], v[72:75], a[56:59], v[176:179]
    ds_read_b64_tr_b16 v[88:89], v29 offset:49152
    buffer_load_dwordx4 v17, s[12:15], s58 offen offset:1024 lds
    s_waitcnt lgkmcnt(7)
    v_mfma_f32_16x16x32_bf16 v[184:187], v[72:75], a[60:63], v[184:187]
    ds_read_b64_tr_b16 v[90:91], v29 offset:49664
    s_add_u32 m0, s80, 139264
    s_waitcnt lgkmcnt(6)
    v_mfma_f32_16x16x32_bf16 v[192:195], v[76:79], a[48:51], v[192:195]
    ds_read_b64_tr_b16 v[92:93], v29 offset:57344
    v_add_f32_dpp v120, v120, v120 quad_perm:[2,3,0,1] row_mask:0xf bank_mask:0xf
    v_mfma_f32_16x16x32_bf16 v[200:203], v[76:79], a[52:55], v[200:203]
    ds_read_b64_tr_b16 v[94:95], v29 offset:57856
    v_add_f32_dpp v121, v121, v121 quad_perm:[2,3,0,1] row_mask:0xf bank_mask:0xf
    v_mfma_f32_16x16x32_bf16 v[208:211], v[76:79], a[56:59], v[208:211]
    buffer_load_dwordx4 v18, s[16:19], s58 offen offset:0 lds
    v_add_f32_dpp v120, v120, v120 row_half_mirror row_mask:0xf bank_mask:0xf
    v_mfma_f32_16x16x32_bf16 v[216:219], v[76:79], a[60:63], v[216:219]
    v_add_f32_dpp v121, v121, v121 row_half_mirror row_mask:0xf bank_mask:0xf
    v_add_f32_dpp v120, v120, v120 row_mirror row_mask:0xf bank_mask:0xf
    s_waitcnt lgkmcnt(6)
    v_mfma_f32_16x16x32_bf16 v[224:227], v[80:83], a[48:51], v[224:227]
    v_add_f32_dpp v121, v121, v121 row_mirror row_mask:0xf bank_mask:0xf
    v_add_f32_dpp v120, v120, v120 row_bcast:15 row_mask:0xa bank_mask:0xf
    v_mfma_f32_16x16x32_bf16 v[232:235], v[80:83], a[52:55], v[232:235]
    v_add_f32_dpp v121, v121, v121 row_bcast:15 row_mask:0xa bank_mask:0xf
    v_add_f32_dpp v120, v120, v120 row_bcast:31 row_mask:0xc bank_mask:0xf
    v_mfma_f32_16x16x32_bf16 v[240:243], v[80:83], a[56:59], v[240:243]
    v_add_f32_dpp v121, v121, v121 row_bcast:31 row_mask:0xc bank_mask:0xf
    v_mul_f32 v122, 0x3b000000, v120
    v_mfma_f32_16x16x32_bf16 v[248:251], v[80:83], a[60:63], v[248:251]
    buffer_load_dwordx4 v19, s[16:19], s58 offen offset:1024 lds
    s_add_u32 s55, s55, 1
    s_waitcnt vmcnt(10) lgkmcnt(0)
    s_barrier
    v_mfma_f32_16x16x32_bf16 v[164:167], v[84:87], a[48:51], v[164:167]
    ds_read_b64_tr_b16 v[72:73], v138 offset:0
    s_and_b32 s55, s55, 7
    v_mfma_f32_16x16x32_bf16 v[172:175], v[84:87], a[52:55], v[172:175]
    ds_read_b64_tr_b16 v[74:75], v138 offset:512
    s_lshl_b32 s56, s55, 7
    v_mfma_f32_16x16x32_bf16 v[180:183], v[84:87], a[56:59], v[180:183]
    ds_read_b128 a[64:67], v156 offset:0
    s_mul_i32 s57, s55, 196608
    v_mfma_f32_16x16x32_bf16 v[188:191], v[84:87], a[60:63], v[188:191]
    ds_read_b128 a[68:71], v156 offset:2048
    s_mul_i32 s58, s55, s54
    v_mfma_f32_16x16x32_bf16 v[196:199], v[88:91], a[48:51], v[196:199]
    ds_read_b128 a[72:75], v156 offset:4096
    s_add_u32 m0, s79, 24576
    v_mfma_f32_16x16x32_bf16 v[204:207], v[88:91], a[52:55], v[204:207]
    ds_read_b128 a[76:79], v156 offset:6144
    buffer_load_dwordx4 v10, s[4:7], s56 offen offset:0 lds
    v_mfma_f32_16x16x32_bf16 v[212:215], v[88:91], a[56:59], v[212:215]
    ds_read_b64_tr_b16 v[76:77], v138 offset:8192
    v_mul_f32 v123, 0x3b000000, v121
    v_mfma_f32_16x16x32_bf16 v[220:223], v[88:91], a[60:63], v[220:223]
    ds_read_b64_tr_b16 v[78:79], v138 offset:8704
    buffer_load_dwordx4 v11, s[4:7], s56 offen offset:1024 lds
    v_mfma_f32_16x16x32_bf16 v[228:231], v[92:95], a[48:51], v[228:231]
    ds_read_b64_tr_b16 v[80:81], v138 offset:16384
    v_readlane_b32 s62, v122, 63
    v_mfma_f32_16x16x32_bf16 v[236:239], v[92:95], a[52:55], v[236:239]
    ds_read_b64_tr_b16 v[82:83], v138 offset:16896
    v_readlane_b32 s63, v123, 63
    v_mfma_f32_16x16x32_bf16 v[244:247], v[92:95], a[56:59], v[244:247]
    v_cvt_pk_bf16_f32 v128, -v122, -v122
    v_cvt_pk_bf16_f32 v132, -v123, -v123
    v_mfma_f32_16x16x32_bf16 v[252:255], v[92:95], a[60:63], v[252:255]
    v_cmp_ne_u32 vcc, 63, v0
    v_mov_b32 v137, 0x40000000
    s_waitcnt lgkmcnt(7)
    v_mfma_f32_16x16x32_bf16 v[160:163], v[72:75], a[64:67], v[160:163]
    ds_read_b64_tr_b16 v[84:85], v139 offset:0
    buffer_load_dwordx4 v12, s[4:7], s56 offen offset:2048 lds
    s_waitcnt lgkmcnt(7)
    v_mfma_f32_16x16x32_bf16 v[168:171], v[72:75], a[68:71], v[168:171]
    ds_read_b64_tr_b16 v[86:87], v139 offset:512
    v_subrev_f32 v104, s62, v104
    s_waitcnt lgkmcnt(7)
    v_mfma_f32_16x16x32_bf16 v[176:179], v[72:75], a[72:75], v[176:179]
    ds_read_b64_tr_b16 v[88:89], v139 offset:8192
    v_subrev_f32 v112, s63, v112
    s_waitcnt lgkmcnt(7)
    v_mfma_f32_16x16x32_bf16 v[184:187], v[72:75], a[76:79], v[184:187]
    ds_read_b64_tr_b16 v[90:91], v139 offset:8704
    v_subrev_f32 v105, s62, v105
    v_mfma_f32_16x16x32_bf16 v[44:47], v[72:75], v[36:39], v[44:47]
    ds_read_b64_tr_b16 v[92:93], v139 offset:16384
    buffer_load_dwordx4 v13, s[4:7], s56 offen offset:3072 lds
    s_waitcnt lgkmcnt(7)
    v_mfma_f32_16x16x32_bf16 v[192:195], v[76:79], a[64:67], v[192:195]
    ds_read_b64_tr_b16 v[94:95], v139 offset:16896
    s_add_u32 m0, s80, 0
    v_mfma_f32_16x16x32_bf16 v[200:203], v[76:79], a[68:71], v[200:203]
    v_subrev_f32 v113, s63, v113
    v_subrev_f32 v106, s62, v106
    v_mfma_f32_16x16x32_bf16 v[208:211], v[76:79], a[72:75], v[208:211]
    v_subrev_f32 v114, s63, v114
    v_subrev_f32 v107, s62, v107
    v_mfma_f32_16x16x32_bf16 v[216:219], v[76:79], a[76:79], v[216:219]
    v_subrev_f32 v115, s63, v115
    v_subrev_f32 v108, s62, v108
    v_mfma_f32_16x16x32_bf16 v[48:51], v[76:79], v[36:39], v[48:51]
    buffer_load_dwordx4 v14, s[8:11], s57 offen offset:0 lds
    v_subrev_f32 v116, s63, v116
    s_waitcnt lgkmcnt(6)
    v_mfma_f32_16x16x32_bf16 v[224:227], v[80:83], a[64:67], v[224:227]
    v_subrev_f32 v109, s62, v109
    v_subrev_f32 v117, s63, v117
    v_mfma_f32_16x16x32_bf16 v[232:235], v[80:83], a[68:71], v[232:235]
    v_subrev_f32 v110, s62, v110
    v_subrev_f32 v118, s63, v118
    v_mfma_f32_16x16x32_bf16 v[240:243], v[80:83], a[72:75], v[240:243]
    v_subrev_f32 v111, s62, v111
    v_subrev_f32 v119, s63, v119
    v_mfma_f32_16x16x32_bf16 v[248:251], v[80:83], a[76:79], v[248:251]
    v_cndmask_b32 v137, 0, v137, vcc
    v_mul_f32 v120, v104, v104
    v_mfma_f32_16x16x32_bf16 v[52:55], v[80:83], v[36:39], v[52:55]
    buffer_load_dwordx4 v15, s[8:11], s57 offen offset:1024 lds
    s_add_u32 m0, s80, 8192
    s_waitcnt lgkmcnt(4)
    v_mfma_f32_16x16x32_bf16 v[164:167], v[84:87], a[64:67], v[164:167]
    ds_read_b64_tr_b16 v[72:73], v140 offset:0
    v_mul_f32 v121, v112, v112
    v_mfma_f32_16x16x32_bf16 v[172:175], v[84:87], a[68:71], v[172:175]
    ds_read_b64_tr_b16 v[74:75], v140 offset:512
    v_fmac_f32 v120, v105, v105
    v_mfma_f32_16x16x32_bf16 v[180:183], v[84:87], a[72:75], v[180:183]
    ds_read_b128 a[80:83], v157 offset:0
    v_fmac_f32 v121, v113, v113
    v_mfma_f32_16x16x32_bf16 v[188:191], v[84:87], a[76:79], v[188:191]
    ds_read_b128 a[84:87], v157 offset:2048
    buffer_load_dwordx4 v16, s[12:15], s58 offen offset:0 lds
    v_mfma_f32_16x16x32_bf16 v[44:47], v[84:87], v[40:43], v[44:47]
    ds_read_b128 a[88:91], v157 offset:4096
    v_fmac_f32 v120, v106, v106
    s_waitcnt lgkmcnt(7)
    v_mfma_f32_16x16x32_bf16 v[196:199], v[88:91], a[64:67], v[196:199]
    ds_read_b128 a[92:95], v157 offset:6144
    v_fmac_f32 v121, v114, v114
    v_mfma_f32_16x16x32_bf16 v[204:207], v[88:91], a[68:71], v[204:207]
    ds_read_b64_tr_b16 v[76:77], v140 offset:8192
    v_fmac_f32 v120, v107, v107
    v_mfma_f32_16x16x32_bf16 v[212:215], v[88:91], a[72:75], v[212:215]
    ds_read_b64_tr_b16 v[78:79], v140 offset:8704
    buffer_load_dwordx4 v17, s[12:15], s58 offen offset:1024 lds
    v_mfma_f32_16x16x32_bf16 v[220:223], v[88:91], a[76:79], v[220:223]
    ds_read_b64_tr_b16 v[80:81], v140 offset:16384
    s_add_u32 m0, s80, 16384
    v_mfma_f32_16x16x32_bf16 v[48:51], v[88:91], v[40:43], v[48:51]
    ds_read_b64_tr_b16 v[82:83], v140 offset:16896
    v_fmac_f32 v121, v115, v115
    s_waitcnt lgkmcnt(10)
    v_mfma_f32_16x16x32_bf16 v[228:231], v[92:95], a[64:67], v[228:231]
    v_fmac_f32 v120, v108, v108
    v_fmac_f32 v121, v116, v116
    v_mfma_f32_16x16x32_bf16 v[236:239], v[92:95], a[68:71], v[236:239]
    v_fmac_f32 v120, v109, v109
    v_fmac_f32 v121, v117, v117
    v_mfma_f32_16x16x32_bf16 v[244:247], v[92:95], a[72:75], v[244:247]
    buffer_load_dwordx4 v18, s[16:19], s58 offen offset:0 lds
    v_fmac_f32 v120, v110, v110
    v_mfma_f32_16x16x32_bf16 v[252:255], v[92:95], a[76:79], v[252:255]
    v_fmac_f32 v121, v118, v118
    v_fmac_f32 v120, v111, v111
    v_mfma_f32_16x16x32_bf16 v[52:55], v[92:95], v[40:43], v[52:55]
    v_fmac_f32 v121, v119, v119
    v_add_f32_dpp v120, v120, v120 quad_perm:[1,0,3,2] row_mask:0xf bank_mask:0xf
    s_waitcnt lgkmcnt(7)
    v_mfma_f32_16x16x32_bf16 v[160:163], v[72:75], a[80:83], v[160:163]
    ds_read_b64_tr_b16 v[84:85], v141 offset:0
    v_add_f32_dpp v121, v121, v121 quad_perm:[1,0,3,2] row_mask:0xf bank_mask:0xf
    s_waitcnt lgkmcnt(7)
    v_mfma_f32_16x16x32_bf16 v[168:171], v[72:75], a[84:87], v[168:171]
    ds_read_b64_tr_b16 v[86:87], v141 offset:512
    buffer_load_dwordx4 v19, s[16:19], s58 offen offset:1024 lds
    s_waitcnt lgkmcnt(7)
    v_mfma_f32_16x16x32_bf16 v[176:179], v[72:75], a[88:91], v[176:179]
    ds_read_b64_tr_b16 v[88:89], v141 offset:8192
    v_add_f32_dpp v120, v120, v120 quad_perm:[2,3,0,1] row_mask:0xf bank_mask:0xf
    s_waitcnt lgkmcnt(7)
    v_mfma_f32_16x16x32_bf16 v[184:187], v[72:75], a[92:95], v[184:187]
    ds_read_b64_tr_b16 v[90:91], v141 offset:8704
    v_add_f32_dpp v121, v121, v121 quad_perm:[2,3,0,1] row_mask:0xf bank_mask:0xf
    s_waitcnt lgkmcnt(6)
    v_mfma_f32_16x16x32_bf16 v[192:195], v[76:79], a[80:83], v[192:195]
    ds_read_b64_tr_b16 v[92:93], v141 offset:16384
    v_add_f32_dpp v120, v120, v120 row_half_mirror row_mask:0xf bank_mask:0xf
    v_mfma_f32_16x16x32_bf16 v[200:203], v[76:79], a[84:87], v[200:203]
    ds_read_b64_tr_b16 v[94:95], v141 offset:16896
    v_add_f32_dpp v121, v121, v121 row_half_mirror row_mask:0xf bank_mask:0xf
    v_mfma_f32_16x16x32_bf16 v[208:211], v[76:79], a[88:91], v[208:211]
    buffer_load_dword v154, v152, s[20:23], 0 offen
    v_add_f32_dpp v120, v120, v120 row_mirror row_mask:0xf bank_mask:0xf
    v_mfma_f32_16x16x32_bf16 v[216:219], v[76:79], a[92:95], v[216:219]
    buffer_load_dword v154, v152, s[24:27], 0 offen
    s_add_u32 s55, s55, 1
    s_waitcnt lgkmcnt(6)
    v_mfma_f32_16x16x32_bf16 v[224:227], v[80:83], a[80:83], v[224:227]
    s_and_b32 s55, s55, 7
    s_lshl_b32 s56, s55, 7
    v_mfma_f32_16x16x32_bf16 v[232:235], v[80:83], a[84:87], v[232:235]
    s_mul_i32 s57, s55, 196608
    s_mul_i32 s58, s55, s54
    v_mfma_f32_16x16x32_bf16 v[240:243], v[80:83], a[88:91], v[240:243]
    s_add_u32 m0, s79, 65536
    v_add_f32_dpp v121, v121, v121 row_mirror row_mask:0xf bank_mask:0xf
    v_mfma_f32_16x16x32_bf16 v[248:251], v[80:83], a[92:95], v[248:251]
    buffer_load_dwordx4 v10, s[4:7], s56 offen offset:0 lds
    v_add_f32_dpp v120, v120, v120 row_bcast:15 row_mask:0xa bank_mask:0xf
    s_waitcnt vmcnt(13) lgkmcnt(0)
    s_barrier
    v_mfma_f32_16x16x32_bf16 v[164:167], v[84:87], a[80:83], v[164:167]
    ds_read_b64_tr_b16 v[72:73], v138 offset:40960
    buffer_load_dwordx4 v11, s[4:7], s56 offen offset:1024 lds
    v_mfma_f32_16x16x32_bf16 v[172:175], v[84:87], a[84:87], v[172:175]
    ds_read_b64_tr_b16 v[74:75], v138 offset:41472
    v_add_f32_dpp v121, v121, v121 row_bcast:15 row_mask:0xa bank_mask:0xf
    v_mfma_f32_16x16x32_bf16 v[180:183], v[84:87], a[88:91], v[180:183]
    ds_read_b128 a[96:99], v156 offset:40960
    v_add_f32_dpp v120, v120, v120 row_bcast:31 row_mask:0xc bank_mask:0xf
    v_mfma_f32_16x16x32_bf16 v[188:191], v[84:87], a[92:95], v[188:191]
    ds_read_b128 a[100:103], v156 offset:43008
    v_add_f32_dpp v121, v121, v121 row_bcast:31 row_mask:0xc bank_mask:0xf
    v_mfma_f32_16x16x32_bf16 v[196:199], v[88:91], a[80:83], v[196:199]
    ds_read_b128 a[104:107], v156 offset:45056
    v_mul_f32 v120, 0x3b000000, v120
    v_mfma_f32_16x16x32_bf16 v[204:207], v[88:91], a[84:87], v[204:207]
    ds_read_b128 a[108:111], v156 offset:47104
    buffer_load_dwordx4 v12, s[4:7], s56 offen offset:2048 lds
    v_mfma_f32_16x16x32_bf16 v[212:215], v[88:91], a[88:91], v[212:215]
    ds_read_b64_tr_b16 v[76:77], v138 offset:49152
    v_mul_f32 v121, 0x3b000000, v121
    v_mfma_f32_16x16x32_bf16 v[220:223], v[88:91], a[92:95], v[220:223]
    ds_read_b64_tr_b16 v[78:79], v138 offset:49664
    v_add_f32 v120, 0x3727c5ac, v120
    v_mfma_f32_16x16x32_bf16 v[228:231], v[92:95], a[80:83], v[228:231]
    ds_read_b64_tr_b16 v[80:81], v138 offset:57344
    v_add_f32 v121, 0x3727c5ac, v121
    v_mfma_f32_16x16x32_bf16 v[236:239], v[92:95], a[84:87], v[236:239]
    ds_read_b64_tr_b16 v[82:83], v138 offset:57856
    buffer_load_dwordx4 v13, s[4:7], s56 offen offset:3072 lds
    v_mfma_f32_16x16x32_bf16 v[244:247], v[92:95], a[88:91], v[244:247]
    s_add_u32 m0, s80, 40960
    v_mfma_f32_16x16x32_bf16 v[252:255], v[92:95], a[92:95], v[252:255]
    v_rsq_f32 v129, v120
    s_waitcnt lgkmcnt(7)
    v_mfma_f32_16x16x32_bf16 v[160:163], v[72:75], a[96:99], v[160:163]
    ds_read_b64_tr_b16 v[84:85], v139 offset:40960
    s_waitcnt lgkmcnt(7)
    v_mfma_f32_16x16x32_bf16 v[168:171], v[72:75], a[100:103], v[168:171]
    ds_read_b64_tr_b16 v[86:87], v139 offset:41472
    s_waitcnt lgkmcnt(7)
    v_mfma_f32_16x16x32_bf16 v[176:179], v[72:75], a[104:107], v[176:179]
    ds_read_b64_tr_b16 v[88:89], v139 offset:49152
    buffer_load_dwordx4 v14, s[8:11], s57 offen offset:0 lds
    s_waitcnt lgkmcnt(7)
    v_mfma_f32_16x16x32_bf16 v[184:187], v[72:75], a[108:111], v[184:187]
    ds_read_b64_tr_b16 v[90:91], v139 offset:49664
    v_mfma_f32_16x16x32_bf16 v[44:47], v[72:75], v[36:39], v[44:47]
    ds_read_b64_tr_b16 v[92:93], v139 offset:57344
    s_waitcnt lgkmcnt(7)
    v_mfma_f32_16x16x32_bf16 v[192:195], v[76:79], a[96:99], v[192:195]
    ds_read_b64_tr_b16 v[94:95], v139 offset:57856
    v_mfma_f32_16x16x32_bf16 v[200:203], v[76:79], a[100:103], v[200:203]
    buffer_load_dwordx4 v15, s[8:11], s57 offen offset:1024 lds
    s_add_u32 m0, s80, 49152
    v_mfma_f32_16x16x32_bf16 v[208:211], v[76:79], a[104:107], v[208:211]
    v_rsq_f32 v133, v121
    v_mfma_f32_16x16x32_bf16 v[216:219], v[76:79], a[108:111], v[216:219]
    v_mov_b32 v130, s60
    v_mov_b32 v131, s61
    v_mfma_f32_16x16x32_bf16 v[48:51], v[76:79], v[36:39], v[48:51]
    v_mov_b32 v134, s60
    v_mov_b32 v135, s61
    s_waitcnt lgkmcnt(6)
    v_mfma_f32_16x16x32_bf16 v[224:227], v[80:83], a[96:99], v[224:227]
    buffer_store_dwordx4 v[128:131], v137, s[28:31], s44 offen offset:0 sc1
    buffer_store_dwordx4 v[132:135], v137, s[28:31], s44 offen offset:16 sc1
    v_mfma_f32_16x16x32_bf16 v[232:235], v[80:83], a[100:103], v[232:235]
    buffer_load_dwordx4 v16, s[12:15], s58 offen offset:0 lds
    v_mfma_f32_16x16x32_bf16 v[240:243], v[80:83], a[104:107], v[240:243]
    v_mfma_f32_16x16x32_bf16 v[248:251], v[80:83], a[108:111], v[248:251]
    v_mfma_f32_16x16x32_bf16 v[52:55], v[80:83], v[36:39], v[52:55]
    s_waitcnt lgkmcnt(4)
    v_mfma_f32_16x16x32_bf16 v[164:167], v[84:87], a[96:99], v[164:167]
    ds_read_b64_tr_b16 v[72:73], v140 offset:40960
    buffer_load_dwordx4 v17, s[12:15], s58 offen offset:1024 lds
    v_mfma_f32_16x16x32_bf16 v[172:175], v[84:87], a[100:103], v[172:175]
    ds_read_b64_tr_b16 v[74:75], v140 offset:41472
    s_add_u32 m0, s80, 57344
    v_mfma_f32_16x16x32_bf16 v[180:183], v[84:87], a[104:107], v[180:183]
    ds_read_b128 a[112:115], v157 offset:40960
    v_mfma_f32_16x16x32_bf16 v[188:191], v[84:87], a[108:111], v[188:191]
    ds_read_b128 a[116:119], v157 offset:43008
    v_mfma_f32_16x16x32_bf16 v[44:47], v[84:87], v[40:43], v[44:47]
    ds_read_b128 a[120:123], v157 offset:45056
    s_waitcnt lgkmcnt(7)
    v_mfma_f32_16x16x32_bf16 v[196:199], v[88:91], a[96:99], v[196:199]
    ds_read_b128 a[124:127], v157 offset:47104
    buffer_load_dwordx4 v18, s[16:19], s58 offen offset:0 lds
    v_mfma_f32_16x16x32_bf16 v[204:207], v[88:91], a[100:103], v[204:207]
    ds_read_b64_tr_b16 v[76:77], v140 offset:49152
    v_mfma_f32_16x16x32_bf16 v[212:215], v[88:91], a[104:107], v[212:215]
    ds_read_b64_tr_b16 v[78:79], v140 offset:49664
    v_mfma_f32_16x16x32_bf16 v[220:223], v[88:91], a[108:111], v[220:223]
    ds_read_b64_tr_b16 v[80:81], v140 offset:57344
    v_mfma_f32_16x16x32_bf16 v[48:51], v[88:91], v[40:43], v[48:51]
    ds_read_b64_tr_b16 v[82:83], v140 offset:57856
    buffer_load_dwordx4 v19, s[16:19], s58 offen offset:1024 lds
    s_waitcnt lgkmcnt(10)
    v_mfma_f32_16x16x32_bf16 v[228:231], v[92:95], a[96:99], v[228:231]
    s_add_u32 s55, s55, 1
    s_and_b32 s55, s55, 7
    v_mfma_f32_16x16x32_bf16 v[236:239], v[92:95], a[100:103], v[236:239]
    s_lshl_b32 s56, s55, 7
    s_mul_i32 s57, s55, 196608
    v_mfma_f32_16x16x32_bf16 v[244:247], v[92:95], a[104:107], v[244:247]
    s_mul_i32 s58, s55, s54
    s_add_u32 m0, s79, 106496
    v_mfma_f32_16x16x32_bf16 v[252:255], v[92:95], a[108:111], v[252:255]
    v_mfma_f32_16x16x32_bf16 v[52:55], v[92:95], v[40:43], v[52:55]
    buffer_load_dwordx4 v10, s[4:7], s56 offen offset:0 lds
    s_waitcnt lgkmcnt(7)
    v_mfma_f32_16x16x32_bf16 v[160:163], v[72:75], a[112:115], v[160:163]
    ds_read_b64_tr_b16 v[84:85], v141 offset:40960
    s_waitcnt lgkmcnt(7)
    v_mfma_f32_16x16x32_bf16 v[168:171], v[72:75], a[116:119], v[168:171]
    ds_read_b64_tr_b16 v[86:87], v141 offset:41472
    s_waitcnt lgkmcnt(7)
    v_mfma_f32_16x16x32_bf16 v[176:179], v[72:75], a[120:123], v[176:179]
    ds_read_b64_tr_b16 v[88:89], v141 offset:49152
    s_waitcnt lgkmcnt(7)
    v_mfma_f32_16x16x32_bf16 v[184:187], v[72:75], a[124:127], v[184:187]
    ds_read_b64_tr_b16 v[90:91], v141 offset:49664
    buffer_load_dwordx4 v11, s[4:7], s56 offen offset:1024 lds
    s_waitcnt lgkmcnt(6)
    v_mfma_f32_16x16x32_bf16 v[192:195], v[76:79], a[112:115], v[192:195]
    ds_read_b64_tr_b16 v[92:93], v141 offset:57344
    v_mfma_f32_16x16x32_bf16 v[200:203], v[76:79], a[116:119], v[200:203]
    ds_read_b64_tr_b16 v[94:95], v141 offset:57856
    v_mfma_f32_16x16x32_bf16 v[208:211], v[76:79], a[120:123], v[208:211]
    v_mfma_f32_16x16x32_bf16 v[216:219], v[76:79], a[124:127], v[216:219]
    s_waitcnt lgkmcnt(6)
    v_mfma_f32_16x16x32_bf16 v[224:227], v[80:83], a[112:115], v[224:227]
    buffer_load_dwordx4 v12, s[4:7], s56 offen offset:2048 lds
    v_mfma_f32_16x16x32_bf16 v[232:235], v[80:83], a[116:119], v[232:235]
    v_mfma_f32_16x16x32_bf16 v[240:243], v[80:83], a[120:123], v[240:243]
    v_mfma_f32_16x16x32_bf16 v[248:251], v[80:83], a[124:127], v[248:251]
    s_waitcnt vmcnt(17) lgkmcnt(0)
    s_barrier
    v_mfma_f32_16x16x32_bf16 v[164:167], v[84:87], a[112:115], v[164:167]
    ds_read_b64_tr_b16 v[72:73], v26 offset:0
    buffer_load_dwordx4 v13, s[4:7], s56 offen offset:3072 lds
    v_mfma_f32_16x16x32_bf16 v[172:175], v[84:87], a[116:119], v[172:175]
    ds_read_b64_tr_b16 v[74:75], v26 offset:512
    s_add_u32 m0, s80, 81920
    v_mfma_f32_16x16x32_bf16 v[180:183], v[84:87], a[120:123], v[180:183]
    ds_read_b128 a[128:131], v22 offset:0
    v_mfma_f32_16x16x32_bf16 v[188:191], v[84:87], a[124:127], v[188:191]
    ds_read_b128 a[132:135], v22 offset:2048
    v_mfma_f32_16x16x32_bf16 v[196:199], v[88:91], a[112:115], v[196:199]
    ds_read_b128 a[136:139], v22 offset:4096
    v_mfma_f32_16x16x32_bf16 v[204:207], v[88:91], a[116:119], v[204:207]
    ds_read_b128 a[140:143], v22 offset:6144
    buffer_load_dwordx4 v14, s[8:11], s57 offen offset:0 lds
    v_mfma_f32_16x16x32_bf16 v[212:215], v[88:91], a[120:123], v[212:215]
    ds_read_b64_tr_b16 v[76:77], v26 offset:8192
    v_mfma_f32_16x16x32_bf16 v[220:223], v[88:91], a[124:127], v[220:223]
    ds_read_b64_tr_b16 v[78:79], v26 offset:8704
    v_mfma_f32_16x16x32_bf16 v[228:231], v[92:95], a[112:115], v[228:231]
    ds_read_b64_tr_b16 v[80:81], v26 offset:16384
    v_mfma_f32_16x16x32_bf16 v[236:239], v[92:95], a[116:119], v[236:239]
    ds_read_b64_tr_b16 v[82:83], v26 offset:16896
    buffer_load_dwordx4 v15, s[8:11], s57 offen offset:1024 lds
    v_mfma_f32_16x16x32_bf16 v[244:247], v[92:95], a[120:123], v[244:247]
    s_add_u32 m0, s80, 90112
    v_mfma_f32_16x16x32_bf16 v[252:255], v[92:95], a[124:127], v[252:255]
    s_waitcnt lgkmcnt(7)
    v_mfma_f32_16x16x32_bf16 v[160:163], v[72:75], a[128:131], v[160:163]
    ds_read_b64_tr_b16 v[84:85], v27 offset:0
    s_waitcnt lgkmcnt(7)
    v_mfma_f32_16x16x32_bf16 v[168:171], v[72:75], a[132:135], v[168:171]
    ds_read_b64_tr_b16 v[86:87], v27 offset:512
    s_waitcnt lgkmcnt(7)
    v_mfma_f32_16x16x32_bf16 v[176:179], v[72:75], a[136:139], v[176:179]
    ds_read_b64_tr_b16 v[88:89], v27 offset:8192
    buffer_load_dwordx4 v16, s[12:15], s58 offen offset:0 lds
    s_waitcnt lgkmcnt(7)
    v_mfma_f32_16x16x32_bf16 v[184:187], v[72:75], a[140:143], v[184:187]
    ds_read_b64_tr_b16 v[90:91], v27 offset:8704
    v_mfma_f32_16x16x32_bf16 v[44:47], v[72:75], v[36:39], v[44:47]
    ds_read_b64_tr_b16 v[92:93], v27 offset:16384
    s_waitcnt lgkmcnt(7)
    v_mfma_f32_16x16x32_bf16 v[192:195], v[76:79], a[128:131], v[192:195]
    ds_read_b64_tr_b16 v[94:95], v27 offset:16896
    v_mfma_f32_16x16x32_bf16 v[200:203], v[76:79], a[132:135], v[200:203]
    buffer_load_dwordx4 v17, s[12:15], s58 offen offset:1024 lds
    s_add_u32 m0, s80, 98304
    v_mfma_f32_16x16x32_bf16 v[208:211], v[76:79], a[136:139], v[208:211]
    v_mfma_f32_16x16x32_bf16 v[216:219], v[76:79], a[140:143], v[216:219]
    v_mfma_f32_16x16x32_bf16 v[48:51], v[76:79], v[36:39], v[48:51]
    s_waitcnt lgkmcnt(6)
    v_mfma_f32_16x16x32_bf16 v[224:227], v[80:83], a[128:131], v[224:227]
    v_mfma_f32_16x16x32_bf16 v[232:235], v[80:83], a[132:135], v[232:235]
    buffer_load_dwordx4 v18, s[16:19], s58 offen offset:0 lds
    v_mfma_f32_16x16x32_bf16 v[240:243], v[80:83], a[136:139], v[240:243]
    v_mfma_f32_16x16x32_bf16 v[248:251], v[80:83], a[140:143], v[248:251]
    v_mfma_f32_16x16x32_bf16 v[52:55], v[80:83], v[36:39], v[52:55]
    s_waitcnt lgkmcnt(4)
    v_mfma_f32_16x16x32_bf16 v[164:167], v[84:87], a[128:131], v[164:167]
    ds_read_b64_tr_b16 v[72:73], v28 offset:0
    buffer_load_dwordx4 v19, s[16:19], s58 offen offset:1024 lds
    v_mfma_f32_16x16x32_bf16 v[172:175], v[84:87], a[132:135], v[172:175]
    ds_read_b64_tr_b16 v[74:75], v28 offset:512
    s_add_u32 s55, s55, 1
    v_mfma_f32_16x16x32_bf16 v[180:183], v[84:87], a[136:139], v[180:183]
    ds_read_b128 a[144:147], v23 offset:0
    s_and_b32 s55, s55, 7
    v_mfma_f32_16x16x32_bf16 v[188:191], v[84:87], a[140:143], v[188:191]
    ds_read_b128 a[148:151], v23 offset:2048
    s_lshl_b32 s56, s55, 7
    v_mfma_f32_16x16x32_bf16 v[44:47], v[84:87], v[40:43], v[44:47]
    ds_read_b128 a[152:155], v23 offset:4096
    s_mul_i32 s57, s55, 196608
    s_waitcnt lgkmcnt(7)
    v_mfma_f32_16x16x32_bf16 v[196:199], v[88:91], a[128:131], v[196:199]
    ds_read_b128 a[156:159], v23 offset:6144
    s_mul_i32 s58, s55, s54
    v_mfma_f32_16x16x32_bf16 v[204:207], v[88:91], a[132:135], v[204:207]
    ds_read_b64_tr_b16 v[76:77], v28 offset:8192
    s_add_u32 m0, s79, 147456
    v_mfma_f32_16x16x32_bf16 v[212:215], v[88:91], a[136:139], v[212:215]
    ds_read_b64_tr_b16 v[78:79], v28 offset:8704
    buffer_load_dwordx4 v10, s[4:7], s56 offen offset:0 lds
    v_mfma_f32_16x16x32_bf16 v[220:223], v[88:91], a[140:143], v[220:223]
    ds_read_b64_tr_b16 v[80:81], v28 offset:16384
    v_mfma_f32_16x16x32_bf16 v[48:51], v[88:91], v[40:43], v[48:51]
    ds_read_b64_tr_b16 v[82:83], v28 offset:16896
    buffer_load_dwordx4 v11, s[4:7], s56 offen offset:1024 lds
    s_waitcnt lgkmcnt(10)
    v_mfma_f32_16x16x32_bf16 v[228:231], v[92:95], a[128:131], v[228:231]
    v_mfma_f32_16x16x32_bf16 v[236:239], v[92:95], a[132:135], v[236:239]
    v_mfma_f32_16x16x32_bf16 v[244:247], v[92:95], a[136:139], v[244:247]
    v_mfma_f32_16x16x32_bf16 v[252:255], v[92:95], a[140:143], v[252:255]
    v_mfma_f32_16x16x32_bf16 v[52:55], v[92:95], v[40:43], v[52:55]
    buffer_load_dwordx4 v12, s[4:7], s56 offen offset:2048 lds
    s_waitcnt lgkmcnt(7)
    v_mfma_f32_16x16x32_bf16 v[160:163], v[72:75], a[144:147], v[160:163]
    ds_read_b64_tr_b16 v[84:85], v29 offset:0
    s_waitcnt lgkmcnt(7)
    v_mfma_f32_16x16x32_bf16 v[168:171], v[72:75], a[148:151], v[168:171]
    ds_read_b64_tr_b16 v[86:87], v29 offset:512
    s_waitcnt lgkmcnt(7)
    v_mfma_f32_16x16x32_bf16 v[176:179], v[72:75], a[152:155], v[176:179]
    ds_read_b64_tr_b16 v[88:89], v29 offset:8192
    s_waitcnt lgkmcnt(7)
    v_mfma_f32_16x16x32_bf16 v[184:187], v[72:75], a[156:159], v[184:187]
    ds_read_b64_tr_b16 v[90:91], v29 offset:8704
    buffer_load_dwordx4 v13, s[4:7], s56 offen offset:3072 lds
    s_waitcnt lgkmcnt(6)
    v_mfma_f32_16x16x32_bf16 v[192:195], v[76:79], a[144:147], v[192:195]
    ds_read_b64_tr_b16 v[92:93], v29 offset:16384
    s_add_u32 m0, s80, 122880
    v_mfma_f32_16x16x32_bf16 v[200:203], v[76:79], a[148:151], v[200:203]
    ds_read_b64_tr_b16 v[94:95], v29 offset:16896
    v_mfma_f32_16x16x32_bf16 v[208:211], v[76:79], a[152:155], v[208:211]
    v_mfma_f32_16x16x32_bf16 v[216:219], v[76:79], a[156:159], v[216:219]
    s_waitcnt lgkmcnt(6)
    v_mfma_f32_16x16x32_bf16 v[224:227], v[80:83], a[144:147], v[224:227]
    buffer_load_dwordx4 v14, s[8:11], s57 offen offset:0 lds
    v_mfma_f32_16x16x32_bf16 v[232:235], v[80:83], a[148:151], v[232:235]
    v_mfma_f32_16x16x32_bf16 v[240:243], v[80:83], a[152:155], v[240:243]
    v_mfma_f32_16x16x32_bf16 v[248:251], v[80:83], a[156:159], v[248:251]
    s_waitcnt vmcnt(15) lgkmcnt(0)
    s_barrier
    v_mfma_f32_16x16x32_bf16 v[164:167], v[84:87], a[144:147], v[164:167]
    ds_read_b64_tr_b16 v[72:73], v26 offset:40960
    buffer_load_dwordx4 v15, s[8:11], s57 offen offset:1024 lds
    v_mfma_f32_16x16x32_bf16 v[172:175], v[84:87], a[148:151], v[172:175]
    ds_read_b64_tr_b16 v[74:75], v26 offset:41472
    s_add_u32 m0, s80, 131072
    v_mfma_f32_16x16x32_bf16 v[180:183], v[84:87], a[152:155], v[180:183]
    ds_read_b128 a[160:163], v22 offset:40960
    v_mfma_f32_16x16x32_bf16 v[188:191], v[84:87], a[156:159], v[188:191]
    ds_read_b128 a[164:167], v22 offset:43008
    v_mfma_f32_16x16x32_bf16 v[196:199], v[88:91], a[144:147], v[196:199]
    ds_read_b128 a[168:171], v22 offset:45056
    v_mfma_f32_16x16x32_bf16 v[204:207], v[88:91], a[148:151], v[204:207]
    ds_read_b128 a[172:175], v22 offset:47104
    buffer_load_dwordx4 v16, s[12:15], s58 offen offset:0 lds
    v_mfma_f32_16x16x32_bf16 v[212:215], v[88:91], a[152:155], v[212:215]
    ds_read_b64_tr_b16 v[76:77], v26 offset:49152
    v_mfma_f32_16x16x32_bf16 v[220:223], v[88:91], a[156:159], v[220:223]
    ds_read_b64_tr_b16 v[78:79], v26 offset:49664
    v_mfma_f32_16x16x32_bf16 v[228:231], v[92:95], a[144:147], v[228:231]
    ds_read_b64_tr_b16 v[80:81], v26 offset:57344
    v_mfma_f32_16x16x32_bf16 v[236:239], v[92:95], a[148:151], v[236:239]
    ds_read_b64_tr_b16 v[82:83], v26 offset:57856
    buffer_load_dwordx4 v17, s[12:15], s58 offen offset:1024 lds
    v_mfma_f32_16x16x32_bf16 v[244:247], v[92:95], a[152:155], v[244:247]
    s_add_u32 m0, s80, 139264
    v_mfma_f32_16x16x32_bf16 v[252:255], v[92:95], a[156:159], v[252:255]
    s_waitcnt lgkmcnt(7)
    v_mfma_f32_16x16x32_bf16 v[160:163], v[72:75], a[160:163], v[160:163]
    ds_read_b64_tr_b16 v[84:85], v27 offset:40960
    v_lshrrev_b32 v8, 5, v0
    s_waitcnt lgkmcnt(7)
    v_mfma_f32_16x16x32_bf16 v[168:171], v[72:75], a[164:167], v[168:171]
    ds_read_b64_tr_b16 v[86:87], v27 offset:41472
    v_and_b32 v9, 0xf0, v1
    s_waitcnt lgkmcnt(7)
    v_mfma_f32_16x16x32_bf16 v[176:179], v[72:75], a[168:171], v[176:179]
    ds_read_b64_tr_b16 v[88:89], v27 offset:49152
    buffer_load_dwordx4 v18, s[16:19], s58 offen offset:0 lds
    s_waitcnt lgkmcnt(7)
    v_mfma_f32_16x16x32_bf16 v[184:187], v[72:75], a[172:175], v[184:187]
    ds_read_b64_tr_b16 v[90:91], v27 offset:49664
    v_lshl_add_u32 v9, v8, 8, v9
    v_mfma_f32_16x16x32_bf16 v[44:47], v[72:75], v[36:39], v[44:47]
    ds_read_b64_tr_b16 v[92:93], v27 offset:57344
    buffer_load_dwordx4 v[56:59], v9, s[28:31], s66 offen offset:0 sc1
    s_waitcnt lgkmcnt(7)
    v_mfma_f32_16x16x32_bf16 v[192:195], v[76:79], a[160:163], v[192:195]
    ds_read_b64_tr_b16 v[94:95], v27 offset:57856
    buffer_load_dwordx4 v[60:63], v9, s[28:31], s66 offen offset:512 sc1
    v_mfma_f32_16x16x32_bf16 v[200:203], v[76:79], a[164:167], v[200:203]
    buffer_load_dwordx4 v19, s[16:19], s58 offen offset:1024 lds
    s_add_u32 s55, s55, 1
    v_mfma_f32_16x16x32_bf16 v[208:211], v[76:79], a[168:171], v[208:211]
    s_and_b32 s55, s55, 7
    s_mul_i32 s59, s55, 229376
    v_mfma_f32_16x16x32_bf16 v[216:219], v[76:79], a[172:175], v[216:219]
    s_add_u32 m0, s80, 0
    v_mfma_f32_16x16x32_bf16 v[48:51], v[76:79], v[36:39], v[48:51]
    s_waitcnt lgkmcnt(6)
    v_mfma_f32_16x16x32_bf16 v[224:227], v[80:83], a[160:163], v[224:227]
    v_mfma_f32_16x16x32_bf16 v[232:235], v[80:83], a[164:167], v[232:235]
    buffer_load_dwordx4 v20, s[20:23], s59 offen offset:0 lds
    v_mfma_f32_16x16x32_bf16 v[240:243], v[80:83], a[168:171], v[240:243]
    v_mfma_f32_16x16x32_bf16 v[248:251], v[80:83], a[172:175], v[248:251]
    v_mfma_f32_16x16x32_bf16 v[52:55], v[80:83], v[36:39], v[52:55]
    s_waitcnt lgkmcnt(4)
    v_mfma_f32_16x16x32_bf16 v[164:167], v[84:87], a[160:163], v[164:167]
    ds_read_b64_tr_b16 v[72:73], v28 offset:40960
    buffer_load_dwordx4 v21, s[20:23], s59 offen offset:1024 lds
    v_mfma_f32_16x16x32_bf16 v[172:175], v[84:87], a[164:167], v[172:175]
    ds_read_b64_tr_b16 v[74:75], v28 offset:41472
    s_add_u32 m0, s80, 8192
    v_mfma_f32_16x16x32_bf16 v[180:183], v[84:87], a[168:171], v[180:183]
    ds_read_b128 a[176:179], v23 offset:40960
    v_mfma_f32_16x16x32_bf16 v[188:191], v[84:87], a[172:175], v[188:191]
    ds_read_b128 a[180:183], v23 offset:43008
    v_mfma_f32_16x16x32_bf16 v[44:47], v[84:87], v[40:43], v[44:47]
    ds_read_b128 a[184:187], v23 offset:45056
    s_waitcnt lgkmcnt(7)
    v_mfma_f32_16x16x32_bf16 v[196:199], v[88:91], a[160:163], v[196:199]
    ds_read_b128 a[188:191], v23 offset:47104
    buffer_load_dwordx4 v20, s[24:27], s59 offen offset:0 lds
    v_mfma_f32_16x16x32_bf16 v[204:207], v[88:91], a[164:167], v[204:207]
    ds_read_b64_tr_b16 v[76:77], v28 offset:49152
    v_mfma_f32_16x16x32_bf16 v[212:215], v[88:91], a[168:171], v[212:215]
    ds_read_b64_tr_b16 v[78:79], v28 offset:49664
    v_mfma_f32_16x16x32_bf16 v[220:223], v[88:91], a[172:175], v[220:223]
    ds_read_b64_tr_b16 v[80:81], v28 offset:57344
    v_mfma_f32_16x16x32_bf16 v[48:51], v[88:91], v[40:43], v[48:51]
    ds_read_b64_tr_b16 v[82:83], v28 offset:57856
    buffer_load_dwordx4 v21, s[24:27], s59 offen offset:1024 lds
    s_waitcnt lgkmcnt(10)
    v_mfma_f32_16x16x32_bf16 v[228:231], v[92:95], a[160:163], v[228:231]
    s_add_u32 s55, s55, 1
    s_and_b32 s55, s55, 7
    v_mfma_f32_16x16x32_bf16 v[236:239], v[92:95], a[164:167], v[236:239]
    s_mul_i32 s59, s55, 229376
    s_add_u32 m0, s80, 16384
    v_mfma_f32_16x16x32_bf16 v[244:247], v[92:95], a[168:171], v[244:247]
    v_mfma_f32_16x16x32_bf16 v[252:255], v[92:95], a[172:175], v[252:255]
    v_mfma_f32_16x16x32_bf16 v[52:55], v[92:95], v[40:43], v[52:55]
    buffer_load_dwordx4 v20, s[20:23], s59 offen offset:0 lds
    s_waitcnt lgkmcnt(7)
    v_mfma_f32_16x16x32_bf16 v[160:163], v[72:75], a[176:179], v[160:163]
    ds_read_b64_tr_b16 v[84:85], v29 offset:40960
    s_waitcnt lgkmcnt(7)
    v_mfma_f32_16x16x32_bf16 v[168:171], v[72:75], a[180:183], v[168:171]
    ds_read_b64_tr_b16 v[86:87], v29 offset:41472
    s_waitcnt lgkmcnt(7)
    v_mfma_f32_16x16x32_bf16 v[176:179], v[72:75], a[184:187], v[176:179]
    ds_read_b64_tr_b16 v[88:89], v29 offset:49152
    s_waitcnt lgkmcnt(7)
    v_mfma_f32_16x16x32_bf16 v[184:187], v[72:75], a[188:191], v[184:187]
    ds_read_b64_tr_b16 v[90:91], v29 offset:49664
    buffer_load_dwordx4 v21, s[20:23], s59 offen offset:1024 lds
    s_waitcnt lgkmcnt(6)
    v_mfma_f32_16x16x32_bf16 v[192:195], v[76:79], a[176:179], v[192:195]
    ds_read_b64_tr_b16 v[92:93], v29 offset:57344
    s_add_u32 m0, s80, 24576
    v_mfma_f32_16x16x32_bf16 v[200:203], v[76:79], a[180:183], v[200:203]
    ds_read_b64_tr_b16 v[94:95], v29 offset:57856
    v_mfma_f32_16x16x32_bf16 v[208:211], v[76:79], a[184:187], v[208:211]
    v_mfma_f32_16x16x32_bf16 v[216:219], v[76:79], a[188:191], v[216:219]
    s_waitcnt lgkmcnt(6)
    v_mfma_f32_16x16x32_bf16 v[224:227], v[80:83], a[176:179], v[224:227]
    buffer_load_dwordx4 v20, s[24:27], s59 offen offset:0 lds
    v_mfma_f32_16x16x32_bf16 v[232:235], v[80:83], a[180:183], v[232:235]
    v_mfma_f32_16x16x32_bf16 v[240:243], v[80:83], a[184:187], v[240:243]
    v_mfma_f32_16x16x32_bf16 v[248:251], v[80:83], a[188:191], v[248:251]
    s_waitcnt vmcnt(19) lgkmcnt(0)
    s_barrier
    v_mfma_f32_16x16x32_bf16 v[164:167], v[84:87], a[176:179], v[164:167]
    ds_read_b64_tr_b16 v[72:73], v138 offset:0
    buffer_load_dwordx4 v21, s[24:27], s59 offen offset:1024 lds
    v_mfma_f32_16x16x32_bf16 v[172:175], v[84:87], a[180:183], v[172:175]
    ds_read_b64_tr_b16 v[74:75], v138 offset:512
    s_add_u32 s55, s55, 1
    v_mfma_f32_16x16x32_bf16 v[180:183], v[84:87], a[184:187], v[180:183]
    ds_read_b128 a[192:195], v156 offset:0
    s_and_b32 s55, s55, 7
    v_mfma_f32_16x16x32_bf16 v[188:191], v[84:87], a[188:191], v[188:191]
    ds_read_b128 a[196:199], v156 offset:2048
    s_mul_i32 s59, s55, 229376
    v_mfma_f32_16x16x32_bf16 v[196:199], v[88:91], a[176:179], v[196:199]
    ds_read_b128 a[200:203], v156 offset:4096
    s_add_u32 m0, s80, 49152
    v_mfma_f32_16x16x32_bf16 v[204:207], v[88:91], a[180:183], v[204:207]
    ds_read_b128 a[204:207], v156 offset:6144
    buffer_load_dwordx4 v20, s[20:23], s59 offen offset:0 lds
    v_mfma_f32_16x16x32_bf16 v[212:215], v[88:91], a[184:187], v[212:215]
    ds_read_b64_tr_b16 v[76:77], v138 offset:8192
    v_mfma_f32_16x16x32_bf16 v[220:223], v[88:91], a[188:191], v[220:223]
    ds_read_b64_tr_b16 v[78:79], v138 offset:8704
    v_mfma_f32_16x16x32_bf16 v[228:231], v[92:95], a[176:179], v[228:231]
    ds_read_b64_tr_b16 v[80:81], v138 offset:16384
    v_mfma_f32_16x16x32_bf16 v[236:239], v[92:95], a[180:183], v[236:239]
    ds_read_b64_tr_b16 v[82:83], v138 offset:16896
    buffer_load_dwordx4 v21, s[20:23], s59 offen offset:1024 lds
    v_mfma_f32_16x16x32_bf16 v[244:247], v[92:95], a[184:187], v[244:247]
    s_add_u32 m0, s80, 57344
    v_mfma_f32_16x16x32_bf16 v[252:255], v[92:95], a[188:191], v[252:255]
    s_waitcnt lgkmcnt(7)
    v_mfma_f32_16x16x32_bf16 v[160:163], v[72:75], a[192:195], v[160:163]
    ds_read_b64_tr_b16 v[84:85], v139 offset:0
    s_mul_i32 s45, s48, 196608
    s_waitcnt lgkmcnt(7)
    v_mfma_f32_16x16x32_bf16 v[168:171], v[72:75], a[196:199], v[168:171]
    ds_read_b64_tr_b16 v[86:87], v139 offset:512
    s_bfe_u32 s62, s2, 0x30003
    s_waitcnt lgkmcnt(7)
    v_mfma_f32_16x16x32_bf16 v[176:179], v[72:75], a[200:203], v[176:179]
    ds_read_b64_tr_b16 v[88:89], v139 offset:8192
    buffer_load_dwordx4 v20, s[24:27], s59 offen offset:0 lds
    s_waitcnt lgkmcnt(7)
    v_mfma_f32_16x16x32_bf16 v[184:187], v[72:75], a[204:207], v[184:187]
    ds_read_b64_tr_b16 v[90:91], v139 offset:8704
    s_lshl_b32 s62, s62, 7
    v_mfma_f32_16x16x32_bf16 v[44:47], v[72:75], v[36:39], v[44:47]
    ds_read_b64_tr_b16 v[92:93], v139 offset:16384
    v_lshrrev_b32 v14, 3, v0
    s_waitcnt lgkmcnt(7)
    v_mfma_f32_16x16x32_bf16 v[192:195], v[76:79], a[192:195], v[192:195]
    ds_read_b64_tr_b16 v[94:95], v139 offset:16896
    v_and_b32 v15, 7, v0
    v_mfma_f32_16x16x32_bf16 v[200:203], v[76:79], a[196:199], v[200:203]
    buffer_load_dwordx4 v21, s[24:27], s59 offen offset:1024 lds
    s_add_u32 s55, s55, 1
    v_mfma_f32_16x16x32_bf16 v[208:211], v[76:79], a[200:203], v[208:211]
    s_and_b32 s55, s55, 7
    s_mul_i32 s59, s55, 229376
    v_mfma_f32_16x16x32_bf16 v[216:219], v[76:79], a[204:207], v[216:219]
    s_add_u32 m0, s80, 65536
    v_bfe_u32 v16, v0, 4, 1
    v_mfma_f32_16x16x32_bf16 v[48:51], v[76:79], v[36:39], v[48:51]
    v_lshlrev_b32 v16, 2, v16
    v_xor_b32 v15, v15, v16
    s_waitcnt lgkmcnt(6)
    v_mfma_f32_16x16x32_bf16 v[224:227], v[80:83], a[192:195], v[224:227]
    v_lshlrev_b32 v15, 4, v15
    v_lshl_add_u32 v15, v14, 10, v15
    v_mfma_f32_16x16x32_bf16 v[232:235], v[80:83], a[196:199], v[232:235]
    buffer_load_dwordx4 v20, s[20:23], s59 offen offset:0 lds
    v_add_u32 v13, s62, v15
    v_mfma_f32_16x16x32_bf16 v[240:243], v[80:83], a[200:203], v[240:243]
    v_add_u32 v14, 7168, v13
    v_add_u32 v15, 14336, v13
    v_mfma_f32_16x16x32_bf16 v[248:251], v[80:83], a[204:207], v[248:251]
    v_add_u32 v16, 21504, v13
    v_bfe_u32 v19, v0, 4, 1
    v_mfma_f32_16x16x32_bf16 v[52:55], v[80:83], v[36:39], v[52:55]
    v_bfe_u32 v18, v0, 1, 1
    v_lshl_add_u32 v18, v19, 1, v18
    s_waitcnt lgkmcnt(4)
    v_mfma_f32_16x16x32_bf16 v[164:167], v[84:87], a[192:195], v[164:167]
    ds_read_b64_tr_b16 v[72:73], v140 offset:0
    buffer_load_dwordx4 v21, s[20:23], s59 offen offset:1024 lds
    v_mfma_f32_16x16x32_bf16 v[172:175], v[84:87], a[196:199], v[172:175]
    ds_read_b64_tr_b16 v[74:75], v140 offset:512
    s_add_u32 m0, s80, 73728
    v_mfma_f32_16x16x32_bf16 v[180:183], v[84:87], a[200:203], v[180:183]
    ds_read_b128 a[208:211], v157 offset:0
    v_bfe_u32 v19, v0, 3, 1
    v_mfma_f32_16x16x32_bf16 v[188:191], v[84:87], a[204:207], v[188:191]
    ds_read_b128 a[212:215], v157 offset:2048
    v_xor_b32 v19, s50, v19
    v_mfma_f32_16x16x32_bf16 v[44:47], v[84:87], v[40:43], v[44:47]
    ds_read_b128 a[216:219], v157 offset:4096
    v_lshl_add_u32 v18, v19, 2, v18
    s_waitcnt lgkmcnt(7)
    v_mfma_f32_16x16x32_bf16 v[196:199], v[88:91], a[192:195], v[196:199]
    ds_read_b128 a[220:223], v157 offset:6144
    buffer_load_dwordx4 v20, s[24:27], s59 offen offset:0 lds
    v_mfma_f32_16x16x32_bf16 v[204:207], v[88:91], a[196:199], v[204:207]
    ds_read_b64_tr_b16 v[76:77], v140 offset:8192
    v_and_b32 v19, 1, v0
    v_mfma_f32_16x16x32_bf16 v[212:215], v[88:91], a[200:203], v[212:215]
    ds_read_b64_tr_b16 v[78:79], v140 offset:8704
    v_lshlrev_b32 v19, 3, v19
    v_mfma_f32_16x16x32_bf16 v[220:223], v[88:91], a[204:207], v[220:223]
    ds_read_b64_tr_b16 v[80:81], v140 offset:16384
    v_lshl_add_u32 v18, v18, 4, v19
    v_mfma_f32_16x16x32_bf16 v[48:51], v[88:91], v[40:43], v[48:51]
    ds_read_b64_tr_b16 v[82:83], v140 offset:16896
    buffer_load_dwordx4 v21, s[24:27], s59 offen offset:1024 lds
    s_waitcnt lgkmcnt(10)
    v_mfma_f32_16x16x32_bf16 v[228:231], v[92:95], a[192:195], v[228:231]
    s_lshl2_add_u32 s82, s2, s48
    v_mov_b32 v143, 0x40000000
    v_cmp_gt_u32 s[84:85], 4, v0
    v_mad_u32_u24 v144, s82, 4, v0
    v_lshlrev_b32 v144, 7, v144
    v_cmp_gt_u32 s[86:87], 14, v0
    v_mad_u32_u24 v145, s82, 14, v0
    v_lshlrev_b32 v145, 7, v145
    v_cndmask_b32 v144, v143, v144, s[84:85]
    v_cndmask_b32 v145, v143, v145, s[86:87]
    v_mfma_f32_16x16x32_bf16 v[236:239], v[92:95], a[196:199], v[236:239]
    v_bfe_u32 v19, v0, 2, 2
    v_lshl_add_u32 v18, v19, 7, v18
    v_mfma_f32_16x16x32_bf16 v[244:247], v[92:95], a[200:203], v[244:247]
    buffer_load_dword v146, v145, s[32:35], 0 offen
    v_lshrrev_b32 v19, 5, v0
    v_mfma_f32_16x16x32_bf16 v[252:255], v[92:95], a[204:207], v[252:255]
    v_lshl_add_u32 v18, v19, 9, v18
    v_add_u32 v18, s79, v18
    v_mfma_f32_16x16x32_bf16 v[52:55], v[92:95], v[40:43], v[52:55]
    v_xor_b32 v19, 64, v18
    s_waitcnt lgkmcnt(7)
    v_mfma_f32_16x16x32_bf16 v[160:163], v[72:75], a[208:211], v[160:163]
    ds_read_b64_tr_b16 v[84:85], v141 offset:0
    s_waitcnt lgkmcnt(7)
    v_mfma_f32_16x16x32_bf16 v[168:171], v[72:75], a[212:215], v[168:171]
    ds_read_b64_tr_b16 v[86:87], v141 offset:512
    buffer_load_dword v147, v144, s[36:39], 0 offen
    s_waitcnt lgkmcnt(7)
    v_mfma_f32_16x16x32_bf16 v[176:179], v[72:75], a[216:219], v[176:179]
    ds_read_b64_tr_b16 v[88:89], v141 offset:8192
    s_waitcnt lgkmcnt(7)
    v_mfma_f32_16x16x32_bf16 v[184:187], v[72:75], a[220:223], v[184:187]
    ds_read_b64_tr_b16 v[90:91], v141 offset:8704
    s_waitcnt lgkmcnt(6)
    v_mfma_f32_16x16x32_bf16 v[192:195], v[76:79], a[208:211], v[192:195]
    ds_read_b64_tr_b16 v[92:93], v141 offset:16384
    v_mfma_f32_16x16x32_bf16 v[200:203], v[76:79], a[212:215], v[200:203]
    ds_read_b64_tr_b16 v[94:95], v141 offset:16896
    v_mfma_f32_16x16x32_bf16 v[208:211], v[76:79], a[216:219], v[208:211]
    v_mfma_f32_16x16x32_bf16 v[216:219], v[76:79], a[220:223], v[216:219]
    s_waitcnt lgkmcnt(6)
    v_mfma_f32_16x16x32_bf16 v[224:227], v[80:83], a[208:211], v[224:227]
    v_mfma_f32_16x16x32_bf16 v[232:235], v[80:83], a[212:215], v[232:235]
    v_mfma_f32_16x16x32_bf16 v[240:243], v[80:83], a[216:219], v[240:243]
    v_mfma_f32_16x16x32_bf16 v[248:251], v[80:83], a[220:223], v[248:251]
    s_waitcnt vmcnt(18) lgkmcnt(0)
    s_barrier
    v_mfma_f32_16x16x32_bf16 v[164:167], v[84:87], a[208:211], v[164:167]
    ds_read_b64_tr_b16 v[72:73], v138 offset:40960
    s_add_u32 s55, s55, 1
    v_mfma_f32_16x16x32_bf16 v[172:175], v[84:87], a[212:215], v[172:175]
    ds_read_b64_tr_b16 v[74:75], v138 offset:41472
    s_and_b32 s55, s55, 7
    v_mfma_f32_16x16x32_bf16 v[180:183], v[84:87], a[216:219], v[180:183]
    ds_read_b128 a[224:227], v156 offset:40960
    s_mul_i32 s59, s55, 229376
    v_mfma_f32_16x16x32_bf16 v[188:191], v[84:87], a[220:223], v[188:191]
    ds_read_b128 a[228:231], v156 offset:43008
    s_add_u32 m0, s80, 81920
    v_mfma_f32_16x16x32_bf16 v[196:199], v[88:91], a[208:211], v[196:199]
    ds_read_b128 a[232:235], v156 offset:45056
    buffer_load_dwordx4 v20, s[20:23], s59 offen offset:0 lds
    v_mfma_f32_16x16x32_bf16 v[204:207], v[88:91], a[212:215], v[204:207]
    ds_read_b128 a[236:239], v156 offset:47104
    buffer_load_dwordx4 v21, s[20:23], s59 offen offset:1024 lds
    v_mfma_f32_16x16x32_bf16 v[212:215], v[88:91], a[216:219], v[212:215]
    ds_read_b64_tr_b16 v[76:77], v138 offset:49152
    s_add_u32 m0, s80, 90112
    v_mfma_f32_16x16x32_bf16 v[220:223], v[88:91], a[220:223], v[220:223]
    ds_read_b64_tr_b16 v[78:79], v138 offset:49664
    v_mfma_f32_16x16x32_bf16 v[228:231], v[92:95], a[208:211], v[228:231]
    ds_read_b64_tr_b16 v[80:81], v138 offset:57344
    v_mfma_f32_16x16x32_bf16 v[236:239], v[92:95], a[212:215], v[236:239]
    ds_read_b64_tr_b16 v[82:83], v138 offset:57856
    buffer_load_dwordx4 v20, s[24:27], s59 offen offset:0 lds
    v_mfma_f32_16x16x32_bf16 v[244:247], v[92:95], a[216:219], v[244:247]
    v_mfma_f32_16x16x32_bf16 v[252:255], v[92:95], a[220:223], v[252:255]
L_stat_check:
    v_cmp_eq_u32 s[82:83], s60, v58
    v_cmp_eq_u32 s[84:85], s61, v59
    v_cmp_eq_u32 s[86:87], s60, v62
    v_cmp_eq_u32 vcc, s61, v63
    s_and_b64 s[82:83], s[82:83], s[84:85]
    s_and_b64 s[86:87], s[86:87], vcc
    s_and_b64 s[82:83], s[82:83], s[86:87]
    s_cmp_eq_u64 s[82:83], -1
    s_cbranch_scc0 L_stat_retry
L_stat_ok:
    s_waitcnt lgkmcnt(7)
    v_mfma_f32_16x16x32_bf16 v[160:163], v[72:75], a[224:227], v[160:163]
    ds_read_b64_tr_b16 v[84:85], v139 offset:40960
    buffer_load_dwordx4 v21, s[24:27], s59 offen offset:1024 lds
    s_waitcnt lgkmcnt(7)
    v_mfma_f32_16x16x32_bf16 v[168:171], v[72:75], a[228:231], v[168:171]
    ds_read_b64_tr_b16 v[86:87], v139 offset:41472
    s_add_u32 s55, s55, 1
    s_waitcnt lgkmcnt(7)
    v_mfma_f32_16x16x32_bf16 v[176:179], v[72:75], a[232:235], v[176:179]
    ds_read_b64_tr_b16 v[88:89], v139 offset:49152
    s_and_b32 s55, s55, 7
    s_waitcnt lgkmcnt(7)
    v_mfma_f32_16x16x32_bf16 v[184:187], v[72:75], a[236:239], v[184:187]
    ds_read_b64_tr_b16 v[90:91], v139 offset:49664
    s_mul_i32 s59, s55, 229376
    v_mfma_f32_16x16x32_bf16 v[44:47], v[72:75], v[36:39], v[44:47]
    ds_read_b64_tr_b16 v[92:93], v139 offset:57344
    s_add_u32 m0, s80, 98304
    s_waitcnt lgkmcnt(7)
    v_mfma_f32_16x16x32_bf16 v[192:195], v[76:79], a[224:227], v[192:195]
    ds_read_b64_tr_b16 v[94:95], v139 offset:57856
    buffer_load_dwordx4 v20, s[20:23], s59 offen offset:0 lds
    v_mfma_f32_16x16x32_bf16 v[200:203], v[76:79], a[228:231], v[200:203]
    v_mul_f32 v58, s78, v57
    v_mul_f32 v62, s78, v61
    v_mfma_f32_16x16x32_bf16 v[208:211], v[76:79], a[232:235], v[208:211]
    v_mul_f32 v59, s78, v57
    v_mul_f32 v63, s78, v61
    v_mfma_f32_16x16x32_bf16 v[216:219], v[76:79], a[236:239], v[216:219]
    v_mov_b32 v57, v56
    v_mov_b32 v61, v60
    v_mfma_f32_16x16x32_bf16 v[48:51], v[76:79], v[36:39], v[48:51]
    buffer_load_dwordx4 v21, s[20:23], s59 offen offset:1024 lds
    s_add_u32 m0, s80, 106496
    s_waitcnt lgkmcnt(6)
    v_mfma_f32_16x16x32_bf16 v[224:227], v[80:83], a[224:227], v[224:227]
    v_permlane32_swap_b32 v58, v59
    v_permlane32_swap_b32 v62, v63
    v_mfma_f32_16x16x32_bf16 v[232:235], v[80:83], a[228:231], v[232:235]
    v_mfma_f32_16x16x32_bf16 v[240:243], v[80:83], a[232:235], v[240:243]
    v_mfma_f32_16x16x32_bf16 v[248:251], v[80:83], a[236:239], v[248:251]
    buffer_load_dwordx4 v20, s[24:27], s59 offen offset:0 lds
    v_mfma_f32_16x16x32_bf16 v[52:55], v[80:83], v[36:39], v[52:55]
    s_waitcnt lgkmcnt(4)
    v_mfma_f32_16x16x32_bf16 v[164:167], v[84:87], a[224:227], v[164:167]
    ds_read_b64_tr_b16 v[72:73], v140 offset:40960
    v_mfma_f32_16x16x32_bf16 v[172:175], v[84:87], a[228:231], v[172:175]
    ds_read_b64_tr_b16 v[74:75], v140 offset:41472
    v_mfma_f32_16x16x32_bf16 v[180:183], v[84:87], a[232:235], v[180:183]
    ds_read_b128 a[240:243], v157 offset:40960
    v_mfma_f32_16x16x32_bf16 v[188:191], v[84:87], a[236:239], v[188:191]
    ds_read_b128 a[244:247], v157 offset:43008
    buffer_load_dwordx4 v21, s[24:27], s59 offen offset:1024 lds
    v_mfma_f32_16x16x32_bf16 v[44:47], v[84:87], v[40:43], v[44:47]
    ds_read_b128 a[248:251], v157 offset:45056
    s_waitcnt lgkmcnt(7)
    v_mfma_f32_16x16x32_bf16 v[196:199], v[88:91], a[224:227], v[196:199]
    ds_read_b128 a[252:255], v157 offset:47104
    v_mfma_f32_16x16x32_bf16 v[204:207], v[88:91], a[228:231], v[204:207]
    ds_read_b64_tr_b16 v[76:77], v140 offset:49152
    v_mfma_f32_16x16x32_bf16 v[212:215], v[88:91], a[232:235], v[212:215]
    ds_read_b64_tr_b16 v[78:79], v140 offset:49664
    v_cvt_pk_bf16_f32 v2, v44, v45
    v_mfma_f32_16x16x32_bf16 v[220:223], v[88:91], a[236:239], v[220:223]
    ds_read_b64_tr_b16 v[80:81], v140 offset:57344
    v_cvt_pk_bf16_f32 v3, v46, v47
    v_mfma_f32_16x16x32_bf16 v[48:51], v[88:91], v[40:43], v[48:51]
    ds_read_b64_tr_b16 v[82:83], v140 offset:57856
    v_lshlrev_b32 v4, 16, v2
    s_waitcnt lgkmcnt(10)
    v_mfma_f32_16x16x32_bf16 v[228:231], v[92:95], a[224:227], v[228:231]
    v_and_b32 v5, 0xffff0000, v2
    v_lshlrev_b32 v6, 16, v3
    v_mfma_f32_16x16x32_bf16 v[236:239], v[92:95], a[228:231], v[236:239]
    v_and_b32 v7, 0xffff0000, v3
    v_sub_f32 v4, v44, v4
    v_mfma_f32_16x16x32_bf16 v[244:247], v[92:95], a[232:235], v[244:247]
    v_sub_f32 v5, v45, v5
    v_sub_f32 v6, v46, v6
    v_mfma_f32_16x16x32_bf16 v[252:255], v[92:95], a[236:239], v[252:255]
    v_sub_f32 v7, v47, v7
    v_cvt_pk_bf16_f32 v8, v4, v5
    v_mfma_f32_16x16x32_bf16 v[52:55], v[92:95], v[40:43], v[52:55]
    v_cvt_pk_bf16_f32 v9, v6, v7
    s_waitcnt lgkmcnt(7)
    v_mfma_f32_16x16x32_bf16 v[160:163], v[72:75], a[240:243], v[160:163]
    ds_read_b64_tr_b16 v[84:85], v141 offset:40960
    ds_write_b64 v32, v[2:3] offset:0
    s_waitcnt lgkmcnt(8)
    v_mfma_f32_16x16x32_bf16 v[168:171], v[72:75], a[244:247], v[168:171]
    ds_read_b64_tr_b16 v[86:87], v141 offset:41472
    ds_write_b64 v32, v[8:9] offset:64
    s_waitcnt lgkmcnt(9)
    v_mfma_f32_16x16x32_bf16 v[176:179], v[72:75], a[248:251], v[176:179]
    ds_read_b64_tr_b16 v[88:89], v141 offset:49152
    v_cvt_pk_bf16_f32 v2, v48, v49
    s_waitcnt lgkmcnt(9)
    v_mfma_f32_16x16x32_bf16 v[184:187], v[72:75], a[252:255], v[184:187]
    ds_read_b64_tr_b16 v[90:91], v141 offset:49664
    v_cvt_pk_bf16_f32 v3, v50, v51
    s_waitcnt lgkmcnt(8)
    v_mfma_f32_16x16x32_bf16 v[192:195], v[76:79], a[240:243], v[192:195]
    ds_read_b64_tr_b16 v[92:93], v141 offset:57344
    v_lshlrev_b32 v4, 16, v2
    v_mfma_f32_16x16x32_bf16 v[200:203], v[76:79], a[244:247], v[200:203]
    ds_read_b64_tr_b16 v[94:95], v141 offset:57856
    v_and_b32 v5, 0xffff0000, v2
    v_mfma_f32_16x16x32_bf16 v[208:211], v[76:79], a[248:251], v[208:211]
    v_lshlrev_b32 v6, 16, v3
    v_and_b32 v7, 0xffff0000, v3
    v_mfma_f32_16x16x32_bf16 v[216:219], v[76:79], a[252:255], v[216:219]
    v_sub_f32 v4, v48, v4
    v_sub_f32 v5, v49, v5
    s_waitcnt lgkmcnt(8)
    v_mfma_f32_16x16x32_bf16 v[224:227], v[80:83], a[240:243], v[224:227]
    v_sub_f32 v6, v50, v6
    v_sub_f32 v7, v51, v7
    v_mfma_f32_16x16x32_bf16 v[232:235], v[80:83], a[244:247], v[232:235]
    v_cvt_pk_bf16_f32 v8, v4, v5
    v_cvt_pk_bf16_f32 v9, v6, v7
    v_mfma_f32_16x16x32_bf16 v[240:243], v[80:83], a[248:251], v[240:243]
    ds_write_b64 v32, v[2:3] offset:512
    ds_write_b64 v32, v[8:9] offset:576
    v_mfma_f32_16x16x32_bf16 v[248:251], v[80:83], a[252:255], v[248:251]
    v_cvt_pk_bf16_f32 v2, v52, v53
    v_cvt_pk_bf16_f32 v3, v54, v55
    v_lshlrev_b32 v4, 16, v2
    v_and_b32 v5, 0xffff0000, v2
    v_lshlrev_b32 v6, 16, v3
    v_and_b32 v7, 0xffff0000, v3
    v_sub_f32 v4, v52, v4
    v_sub_f32 v5, v53, v5
    v_sub_f32 v6, v54, v6
    v_sub_f32 v7, v55, v7
    v_cvt_pk_bf16_f32 v8, v4, v5
    v_cvt_pk_bf16_f32 v9, v6, v7
    ds_write_b64 v32, v[2:3] offset:1024
    ds_write_b64 v32, v[8:9] offset:1088
    s_waitcnt vmcnt(10) lgkmcnt(0)
    s_barrier
    v_mfma_f32_16x16x32_bf16 v[164:167], v[84:87], a[240:243], v[164:167]
    ds_read_b64_tr_b16 v[64:65], v33 offset:0
    v_mfma_f32_16x16x32_bf16 v[172:175], v[84:87], a[244:247], v[172:175]
    ds_read_b64_tr_b16 v[66:67], v33 offset:512
    v_mfma_f32_16x16x32_bf16 v[180:183], v[84:87], a[248:251], v[180:183]
    ds_read_b64_tr_b16 v[68:69], v33 offset:1024
    v_mfma_f32_16x16x32_bf16 v[188:191], v[84:87], a[252:255], v[188:191]
    ds_read_b64_tr_b16 v[72:73], v26 offset:0
    v_mfma_f32_16x16x32_bf16 v[196:199], v[88:91], a[240:243], v[196:199]
    ds_read_b64_tr_b16 v[74:75], v26 offset:512
    v_mfma_f32_16x16x32_bf16 v[204:207], v[88:91], a[244:247], v[204:207]
    ds_read_b64_tr_b16 v[76:77], v26 offset:8192
    v_mfma_f32_16x16x32_bf16 v[212:215], v[88:91], a[248:251], v[212:215]
    ds_read_b64_tr_b16 v[78:79], v26 offset:8704
    v_mfma_f32_16x16x32_bf16 v[220:223], v[88:91], a[252:255], v[220:223]
    v_mfma_f32_16x16x32_bf16 v[228:231], v[92:95], a[240:243], v[228:231]
    v_mfma_f32_16x16x32_bf16 v[236:239], v[92:95], a[244:247], v[236:239]
    v_mfma_f32_16x16x32_bf16 v[244:247], v[92:95], a[248:251], v[244:247]
    v_mfma_f32_16x16x32_bf16 v[252:255], v[92:95], a[252:255], v[252:255]
    s_waitcnt lgkmcnt(6)
    v_mfma_f32_16x16x4_4b_bf16 v[160:175], v[64:65], v[56:57], v[160:175]
    v_mfma_f32_16x16x4_4b_bf16 v[176:191], v[64:65], v[60:61], v[176:191]
    s_waitcnt lgkmcnt(5)
    v_mfma_f32_16x16x4_4b_bf16 v[192:207], v[66:67], v[56:57], v[192:207]
    v_mfma_f32_16x16x4_4b_bf16 v[208:223], v[66:67], v[60:61], v[208:223]
    s_waitcnt lgkmcnt(4)
    v_mfma_f32_16x16x4_4b_bf16 v[224:239], v[68:69], v[56:57], v[224:239]
    v_mfma_f32_16x16x4_4b_bf16 v[240:255], v[68:69], v[60:61], v[240:255]
    s_cmp_eq_u32 s53, 1
    s_cbranch_scc1 L_p2b
    s_waitcnt lgkmcnt(2)
    v_mfma_f32_16x16x32_bf16 v[96:99], v[72:75], a[0:3], 0
    ds_read_b64_tr_b16 v[84:85], v27 offset:0
    v_mul_f32 v160, v58, v160
    v_mul_f32 v161, v58, v161
    v_mul_f32 v162, v58, v162
    v_mfma_f32_16x16x32_bf16 v[104:107], v[72:75], a[4:7], 0
    ds_read_b64_tr_b16 v[86:87], v27 offset:512
    v_mul_f32 v163, v58, v163
    v_mul_f32 v164, v58, v164
    v_mul_f32 v165, v58, v165
    v_mfma_f32_16x16x32_bf16 v[112:115], v[72:75], a[8:11], 0
    ds_read_b64_tr_b16 v[88:89], v27 offset:8192
    v_mul_f32 v166, v58, v166
    v_mul_f32 v167, v58, v167
    v_mul_f32 v168, v59, v168
    v_mfma_f32_16x16x32_bf16 v[120:123], v[72:75], a[12:15], 0
    ds_read_b64_tr_b16 v[90:91], v27 offset:8704
    v_mul_f32 v169, v59, v169
    v_mul_f32 v170, v59, v170
    v_mul_f32 v171, v59, v171
    v_mfma_f32_16x16x32_bf16 v[44:47], v[72:75], v[36:39], 0
    v_mul_f32 v172, v59, v172
    v_mul_f32 v173, v59, v173
    v_mul_f32 v174, v59, v174
    v_mul_f32 v175, v59, v175
    s_waitcnt lgkmcnt(4)
    v_mfma_f32_16x16x32_bf16 v[128:131], v[76:79], a[0:3], 0
    v_cvt_pk_bf16_f32 v160, v160, v161
    v_cvt_pk_bf16_f32 v161, v162, v163
    v_cvt_pk_bf16_f32 v162, v164, v165
    v_cvt_pk_bf16_f32 v163, v166, v167
    v_mfma_f32_16x16x32_bf16 v[136:139], v[76:79], a[4:7], 0
    buffer_store_dwordx4 v[160:163], v30, s[28:31], s68 offen offset:0 sc1
    v_cvt_pk_bf16_f32 v168, v168, v169
    v_cvt_pk_bf16_f32 v169, v170, v171
    v_cvt_pk_bf16_f32 v170, v172, v173
    s_waitcnt vmcnt(9)
    v_mfma_f32_16x16x32_bf16 v[144:147], v[76:79], a[8:11], 0
    v_cvt_pk_bf16_f32 v171, v174, v175
    v_mfma_f32_16x16x32_bf16 v[152:155], v[76:79], a[12:15], 0
    buffer_store_dwordx4 v[168:171], v30, s[28:31], s69 offen offset:0 sc1
    v_mul_f32 v176, v62, v176
    v_mul_f32 v177, v62, v177
    v_mul_f32 v178, v62, v178
    v_mfma_f32_16x16x32_bf16 v[48:51], v[76:79], v[36:39], 0
    v_mul_f32 v179, v62, v179
    v_mul_f32 v180, v62, v180
    v_mul_f32 v181, v62, v181
    v_mul_f32 v182, v62, v182
    s_waitcnt lgkmcnt(2)
    v_mfma_f32_16x16x32_bf16 v[100:103], v[84:87], a[0:3], 0
    ds_read_b64_tr_b16 v[72:73], v28 offset:0
    v_mul_f32 v183, v62, v183
    v_mul_f32 v184, v63, v184
    v_mul_f32 v185, v63, v185
    v_mfma_f32_16x16x32_bf16 v[108:111], v[84:87], a[4:7], 0
    ds_read_b64_tr_b16 v[74:75], v28 offset:512
    v_mul_f32 v186, v63, v186
    v_mul_f32 v187, v63, v187
    v_mul_f32 v188, v63, v188
    v_mfma_f32_16x16x32_bf16 v[116:119], v[84:87], a[8:11], 0
    ds_read_b64_tr_b16 v[76:77], v28 offset:8192
    v_mul_f32 v189, v63, v189
    v_mul_f32 v190, v63, v190
    v_mul_f32 v191, v63, v191
    v_mfma_f32_16x16x32_bf16 v[124:127], v[84:87], a[12:15], 0
    ds_read_b64_tr_b16 v[78:79], v28 offset:8704
    v_cvt_pk_bf16_f32 v176, v176, v177
    v_cvt_pk_bf16_f32 v177, v178, v179
    v_cvt_pk_bf16_f32 v178, v180, v181
    v_mfma_f32_16x16x32_bf16 v[44:47], v[84:87], v[40:43], v[44:47]
    v_cvt_pk_bf16_f32 v179, v182, v183
    s_waitcnt lgkmcnt(4)
    v_mfma_f32_16x16x32_bf16 v[132:135], v[88:91], a[0:3], 0
    buffer_store_dwordx4 v[176:179], v30, s[28:31], s68 offen offset:1024 sc1
    v_cvt_pk_bf16_f32 v184, v184, v185
    v_cvt_pk_bf16_f32 v185, v186, v187
    v_cvt_pk_bf16_f32 v186, v188, v189
    v_mfma_f32_16x16x32_bf16 v[140:143], v[88:91], a[4:7], 0
    v_cvt_pk_bf16_f32 v187, v190, v191
    v_mfma_f32_16x16x32_bf16 v[148:151], v[88:91], a[8:11], 0
    buffer_store_dwordx4 v[184:187], v30, s[28:31], s69 offen offset:1024 sc1
    v_mfma_f32_16x16x32_bf16 v[156:159], v[88:91], a[12:15], 0
    v_mfma_f32_16x16x32_bf16 v[48:51], v[88:91], v[40:43], v[48:51]
    s_waitcnt lgkmcnt(2)
    v_mfma_f32_16x16x32_bf16 v[96:99], v[72:75], a[16:19], v[96:99]
    ds_read_b64_tr_b16 v[84:85], v29 offset:0
    v_mfma_f32_16x16x32_bf16 v[104:107], v[72:75], a[20:23], v[104:107]
    ds_read_b64_tr_b16 v[86:87], v29 offset:512
    v_mfma_f32_16x16x32_bf16 v[112:115], v[72:75], a[24:27], v[112:115]
    ds_read_b64_tr_b16 v[88:89], v29 offset:8192
    v_mfma_f32_16x16x32_bf16 v[120:123], v[72:75], a[28:31], v[120:123]
    ds_read_b64_tr_b16 v[90:91], v29 offset:8704
    s_waitcnt lgkmcnt(4)
    v_mfma_f32_16x16x32_bf16 v[128:131], v[76:79], a[16:19], v[128:131]
    v_mfma_f32_16x16x32_bf16 v[136:139], v[76:79], a[20:23], v[136:139]
    v_mfma_f32_16x16x32_bf16 v[144:147], v[76:79], a[24:27], v[144:147]
    v_mfma_f32_16x16x32_bf16 v[152:155], v[76:79], a[28:31], v[152:155]
    s_waitcnt lgkmcnt(2)
    v_mfma_f32_16x16x32_bf16 v[100:103], v[84:87], a[16:19], v[100:103]
    ds_read_b64_tr_b16 v[72:73], v26 offset:16384
    s_and_b32 s82, s2, 7
    v_mfma_f32_16x16x32_bf16 v[108:111], v[84:87], a[20:23], v[108:111]
    ds_read_b64_tr_b16 v[74:75], v26 offset:16896
    s_lshr_b32 s83, s2, 6
    v_mfma_f32_16x16x32_bf16 v[116:119], v[84:87], a[24:27], v[116:119]
    ds_read_b64_tr_b16 v[76:77], v26 offset:24576
    s_lshl2_add_u32 s82, s82, s83
    v_mfma_f32_16x16x32_bf16 v[124:127], v[84:87], a[28:31], v[124:127]
    ds_read_b64_tr_b16 v[78:79], v26 offset:25088
    s_bfe_u32 s83, s2, 0x30003
    s_waitcnt lgkmcnt(4)
    v_mfma_f32_16x16x32_bf16 v[132:135], v[88:91], a[16:19], v[132:135]
    v_cmp_eq_u32 s[46:47], 0, v0
    v_mov_b32 v17, 0x40000000
    v_mfma_f32_16x16x32_bf16 v[140:143], v[88:91], a[20:23], v[140:143]
    s_lshl2_add_u32 s44, s2, s48
    s_lshl_b32 s44, s44, 7
    v_mfma_f32_16x16x32_bf16 v[148:151], v[88:91], a[24:27], v[148:151]
    v_cndmask_b32 v17, v17, 0, s[46:47]
    s_lshr_b32 s84, s82, 2
    v_mfma_f32_16x16x32_bf16 v[156:159], v[88:91], a[28:31], v[156:159]
    s_mul_i32 s85, s84, 43
    s_lshr_b32 s85, s85, 7
    s_waitcnt lgkmcnt(2)
    v_mfma_f32_16x16x32_bf16 v[96:99], v[72:75], a[32:35], v[96:99]
    ds_read_b64_tr_b16 v[84:85], v27 offset:16384
    s_mul_i32 s86, s85, 190
    v_mfma_f32_16x16x32_bf16 v[104:107], v[72:75], a[36:39], v[104:107]
    ds_read_b64_tr_b16 v[86:87], v27 offset:16896
    s_lshl_b32 s87, s84, 6
    v_mfma_f32_16x16x32_bf16 v[112:115], v[72:75], a[40:43], v[112:115]
    ds_read_b64_tr_b16 v[88:89], v27 offset:24576
    s_sub_u32 s86, s87, s86
    v_mfma_f32_16x16x32_bf16 v[120:123], v[72:75], a[44:47], v[120:123]
    ds_read_b64_tr_b16 v[90:91], v27 offset:25088
    v_mov_b32 v22, s86
    v_mfma_f32_16x16x32_bf16 v[44:47], v[72:75], v[36:39], v[44:47]
    s_add_u32 s85, s84, 8
    s_mul_i32 s85, s85, 43
    s_waitcnt lgkmcnt(4)
    v_mfma_f32_16x16x32_bf16 v[128:131], v[76:79], a[32:35], v[128:131]
    s_lshr_b32 s85, s85, 7
    s_mul_i32 s86, s85, 190
    v_mfma_f32_16x16x32_bf16 v[136:139], v[76:79], a[36:39], v[136:139]
    s_add_u32 s87, s87, 512
    s_sub_u32 s86, s87, s86
    v_mfma_f32_16x16x32_bf16 v[144:147], v[76:79], a[40:43], v[144:147]
    s_lshl1_add_u32 s85, s85, 184
    s_cmp_lt_u32 s84, 4
    s_cselect_b32 s86, s86, s85
    v_mfma_f32_16x16x32_bf16 v[152:155], v[76:79], a[44:47], v[152:155]
    v_mov_b32 v190, s86
    s_add_u32 s85, s84, 16
    v_mfma_f32_16x16x32_bf16 v[48:51], v[76:79], v[36:39], v[48:51]
    s_mul_i32 s85, s85, 43
    s_lshr_b32 s85, s85, 7
    s_waitcnt lgkmcnt(2)
    v_mfma_f32_16x16x32_bf16 v[100:103], v[84:87], a[32:35], v[100:103]
    ds_read_b64_tr_b16 v[72:73], v28 offset:16384
    v_mul_f32 v192, v192, v224
    v_mul_f32 v193, v193, v225
    v_mul_f32 v194, v194, v226
    v_mfma_f32_16x16x32_bf16 v[108:111], v[84:87], a[36:39], v[108:111]
    ds_read_b64_tr_b16 v[74:75], v28 offset:16896
    v_mul_f32 v195, v195, v227
    v_mul_f32 v196, v196, v228
    v_mul_f32 v197, v197, v229
    v_mfma_f32_16x16x32_bf16 v[116:119], v[84:87], a[40:43], v[116:119]
    ds_read_b64_tr_b16 v[76:77], v28 offset:24576
    v_mul_f32 v198, v198, v230
    v_mul_f32 v199, v199, v231
    v_mul_f32 v200, v200, v232
    v_mfma_f32_16x16x32_bf16 v[124:127], v[84:87], a[44:47], v[124:127]
    ds_read_b64_tr_b16 v[78:79], v28 offset:25088
    v_mul_f32 v201, v201, v233
    v_mul_f32 v202, v202, v234
    v_mul_f32 v203, v203, v235
    v_mfma_f32_16x16x32_bf16 v[44:47], v[84:87], v[40:43], v[44:47]
    v_mul_f32 v204, v204, v236
    v_mul_f32 v205, v205, v237
    v_mul_f32 v206, v206, v238
    v_mul_f32 v207, v207, v239
    s_waitcnt lgkmcnt(4)
    v_mfma_f32_16x16x32_bf16 v[132:135], v[88:91], a[32:35], v[132:135]
    v_cvt_pk_bf16_f32 v192, v192, v193
    v_cvt_pk_bf16_f32 v193, v194, v195
    v_cvt_pk_bf16_f32 v194, v196, v197
    v_cvt_pk_bf16_f32 v195, v198, v199
    v_mfma_f32_16x16x32_bf16 v[140:143], v[88:91], a[36:39], v[140:143]
    buffer_store_dwordx4 v[192:195], v31, s[28:31], s74 offen offset:0 sc1
    v_cvt_pk_bf16_f32 v200, v200, v201
    v_cvt_pk_bf16_f32 v201, v202, v203
    v_cvt_pk_bf16_f32 v202, v204, v205
    v_mfma_f32_16x16x32_bf16 v[148:151], v[88:91], a[40:43], v[148:151]
    v_cvt_pk_bf16_f32 v203, v206, v207
    s_lshl1_add_u32 s85, s85, 184
    v_mov_b32 v191, s85
    v_bfe_u32 v24, v0, 3, 2
    v_mfma_f32_16x16x32_bf16 v[156:159], v[88:91], a[44:47], v[156:159]
    buffer_store_dwordx4 v[200:203], v31, s[28:31], s74 offen offset:256 sc1
    v_mul_f32 v208, v208, v240
    v_mul_f32 v209, v209, v241
    v_mul_f32 v210, v210, v242
    v_mfma_f32_16x16x32_bf16 v[48:51], v[88:91], v[40:43], v[48:51]
    v_mul_f32 v211, v211, v243
    v_mul_f32 v212, v212, v244
    v_mul_f32 v213, v213, v245
    v_mul_f32 v214, v214, v246
    s_waitcnt lgkmcnt(2)
    v_mfma_f32_16x16x32_bf16 v[96:99], v[72:75], a[48:51], v[96:99]
    ds_read_b64_tr_b16 v[84:85], v29 offset:16384
    v_mul_f32 v215, v215, v247
    v_mul_f32 v216, v216, v248
    v_mul_f32 v217, v217, v249
    v_mfma_f32_16x16x32_bf16 v[104:107], v[72:75], a[52:55], v[104:107]
    ds_read_b64_tr_b16 v[86:87], v29 offset:16896
    v_mul_f32 v218, v218, v250
    v_mul_f32 v219, v219, v251
    v_mul_f32 v220, v220, v252
    v_mfma_f32_16x16x32_bf16 v[112:115], v[72:75], a[56:59], v[112:115]
    ds_read_b64_tr_b16 v[88:89], v29 offset:24576
    v_mul_f32 v221, v221, v253
    v_mul_f32 v222, v222, v254
    v_mul_f32 v223, v223, v255
    v_mfma_f32_16x16x32_bf16 v[120:123], v[72:75], a[60:63], v[120:123]
    ds_read_b64_tr_b16 v[90:91], v29 offset:25088
    v_cvt_pk_bf16_f32 v208, v208, v209
    v_cvt_pk_bf16_f32 v209, v210, v211
    v_cvt_pk_bf16_f32 v210, v212, v213
    s_waitcnt lgkmcnt(4)
    v_mfma_f32_16x16x32_bf16 v[128:131], v[76:79], a[48:51], v[128:131]
    v_cvt_pk_bf16_f32 v211, v214, v215
    v_cmp_eq_u32 s[46:47], 1, v24
    s_lshl_b32 s84, s83, 1
    s_sub_u32 s84, s84, 2
    v_mfma_f32_16x16x32_bf16 v[136:139], v[76:79], a[52:55], v[136:139]
    buffer_store_dwordx4 v[208:211], v31, s[28:31], s75 offen offset:0 sc1
    v_cvt_pk_bf16_f32 v216, v216, v217
    v_cvt_pk_bf16_f32 v217, v218, v219
    v_cvt_pk_bf16_f32 v218, v220, v221
    v_mfma_f32_16x16x32_bf16 v[144:147], v[76:79], a[56:59], v[144:147]
    v_cvt_pk_bf16_f32 v219, v222, v223
    v_cndmask_b32 v22, v22, v190, s[46:47]
    v_cmp_eq_u32 s[46:47], 2, v24
    v_bfe_u32 v190, v0, 1, 2
    v_mfma_f32_16x16x32_bf16 v[152:155], v[76:79], a[60:63], v[152:155]
    buffer_store_dwordx4 v[216:219], v31, s[28:31], s75 offen offset:256 sc1
    v_add_u32 v23, s84, v190
    v_cndmask_b32 v22, v22, v191, s[46:47]
    v_max_i32 v23, 0, v23
    s_waitcnt lgkmcnt(2)
    v_mfma_f32_16x16x32_bf16 v[100:103], v[84:87], a[48:51], v[100:103]
    ds_read_b64_tr_b16 v[72:73], v26 offset:49152
    s_add_u32 s55, s55, 1
    v_mfma_f32_16x16x32_bf16 v[108:111], v[84:87], a[52:55], v[108:111]
    ds_read_b64_tr_b16 v[74:75], v26 offset:49664
    s_and_b32 s55, s55, 7
    v_mfma_f32_16x16x32_bf16 v[116:119], v[84:87], a[56:59], v[116:119]
    ds_read_b64_tr_b16 v[76:77], v26 offset:57344
    s_mul_i32 s59, s55, 229376
    v_mfma_f32_16x16x32_bf16 v[124:127], v[84:87], a[60:63], v[124:127]
    ds_read_b64_tr_b16 v[78:79], v26 offset:57856
    s_add_u32 m0, s80, 131072
    s_waitcnt lgkmcnt(4)
    v_mfma_f32_16x16x32_bf16 v[132:135], v[88:91], a[48:51], v[132:135]
    buffer_load_dwordx4 v20, s[20:23], s59 offen offset:0 lds
    v_lshrrev_b32 v191, 3, v23
    v_mfma_f32_16x16x32_bf16 v[140:143], v[88:91], a[52:55], v[140:143]
    buffer_load_dwordx4 v21, s[20:23], s59 offen offset:1024 lds
    s_add_u32 m0, s80, 139264
    v_mfma_f32_16x16x32_bf16 v[148:151], v[88:91], a[56:59], v[148:151]
    v_add_u32 v26, 0x10000, v26
    v_add_u32 v22, v22, v191
    v_mfma_f32_16x16x32_bf16 v[156:159], v[88:91], a[60:63], v[156:159]
    v_and_b32 v23, 7, v23
    v_lshl_add_u32 v22, v23, 3, v22
    s_waitcnt lgkmcnt(2)
    v_mfma_f32_16x16x32_bf16 v[96:99], v[72:75], a[64:67], v[96:99]
    ds_read_b64_tr_b16 v[84:85], v27 offset:49152
    buffer_load_dwordx4 v20, s[24:27], s59 offen offset:0 lds
    v_mfma_f32_16x16x32_bf16 v[104:107], v[72:75], a[68:71], v[104:107]
    ds_read_b64_tr_b16 v[86:87], v27 offset:49664
    v_and_b32 v191, 1, v0
    v_mfma_f32_16x16x32_bf16 v[112:115], v[72:75], a[72:75], v[112:115]
    ds_read_b64_tr_b16 v[88:89], v27 offset:57344
    v_lshl_add_u32 v22, v22, 2, v191
    v_mfma_f32_16x16x32_bf16 v[120:123], v[72:75], a[76:79], v[120:123]
    ds_read_b64_tr_b16 v[90:91], v27 offset:57856
    s_and_b32 s84, s82, 2
    v_mfma_f32_16x16x32_bf16 v[44:47], v[72:75], v[36:39], v[44:47]
    buffer_load_dwordx4 v21, s[24:27], s59 offen offset:1024 lds
    s_add_u32 s55, s55, 1
    s_waitcnt lgkmcnt(4)
    v_mfma_f32_16x16x32_bf16 v[128:131], v[76:79], a[64:67], v[128:131]
    s_and_b32 s55, s55, 7
    s_mul_i32 s59, s55, 229376
    v_mfma_f32_16x16x32_bf16 v[136:139], v[76:79], a[68:71], v[136:139]
    v_add_u32 v27, 0x10000, v27
    s_add_u32 m0, s80, 147456
    v_mfma_f32_16x16x32_bf16 v[144:147], v[76:79], a[72:75], v[144:147]
    v_add_u32 v22, s84, v22
    s_lshr_b32 s84, s82, 4
    v_mfma_f32_16x16x32_bf16 v[152:155], v[76:79], a[76:79], v[152:155]
    buffer_load_dwordx4 v20, s[20:23], s59 offen offset:0 lds
    s_bfe_u32 s85, s82, 0x30001
    v_mfma_f32_16x16x32_bf16 v[48:51], v[76:79], v[36:39], v[48:51]
    s_lshl3_add_u32 s84, s85, s84
    s_lshl1_add_u32 s84, s48, s84
    s_waitcnt lgkmcnt(2)
    v_mfma_f32_16x16x32_bf16 v[100:103], v[84:87], a[64:67], v[100:103]
    ds_read_b64_tr_b16 v[72:73], v28 offset:49152
    s_and_b32 s85, s82, 1
    v_mfma_f32_16x16x32_bf16 v[108:111], v[84:87], a[68:71], v[108:111]
    ds_read_b64_tr_b16 v[74:75], v28 offset:49664
    s_lshl2_add_u32 s84, s84, s85
    v_mfma_f32_16x16x32_bf16 v[116:119], v[84:87], a[72:75], v[116:119]
    ds_read_b64_tr_b16 v[76:77], v28 offset:57344
    buffer_load_dwordx4 v21, s[20:23], s59 offen offset:1024 lds
    v_mfma_f32_16x16x32_bf16 v[124:127], v[84:87], a[76:79], v[124:127]
    ds_read_b64_tr_b16 v[78:79], v28 offset:57856
    s_add_u32 m0, s80, 155648
    v_mfma_f32_16x16x32_bf16 v[44:47], v[84:87], v[40:43], v[44:47]
    v_lshlrev_b32 v190, 8, v190
    v_lshl_add_u32 v190, v191, 1, v190
    s_waitcnt lgkmcnt(4)
    v_mfma_f32_16x16x32_bf16 v[132:135], v[88:91], a[64:67], v[132:135]
    v_add_u32 v23, s84, v190
    v_cmp_eq_u32 s[46:47], 3, v24
    v_mfma_f32_16x16x32_bf16 v[140:143], v[88:91], a[68:71], v[140:143]
    v_add_u32 v28, 0x10000, v28
    v_bfe_u32 v190, v0, 2, 2
    v_mfma_f32_16x16x32_bf16 v[148:151], v[88:91], a[72:75], v[148:151]
    buffer_load_dwordx4 v20, s[24:27], s59 offen offset:0 lds
    v_and_b32 v191, 3, v0
    v_mfma_f32_16x16x32_bf16 v[156:159], v[88:91], a[76:79], v[156:159]
    v_cndmask_b32 v22, v22, v23, s[46:47]
    s_mov_b32 s86, 131072
    v_mfma_f32_16x16x32_bf16 v[48:51], v[88:91], v[40:43], v[48:51]
    s_mov_b32 s87, 393216
    v_lshl_add_u32 v22, v22, 7, s86
    s_waitcnt lgkmcnt(2)
    v_mfma_f32_16x16x32_bf16 v[96:99], v[72:75], a[80:83], v[96:99]
    ds_read_b64_tr_b16 v[84:85], v29 offset:49152
    buffer_load_dwordx4 v21, s[24:27], s59 offen offset:1024 lds
    v_mfma_f32_16x16x32_bf16 v[104:107], v[72:75], a[84:87], v[104:107]
    ds_read_b64_tr_b16 v[86:87], v29 offset:49664
    v_lshl_add_u32 v23, v23, 7, s87
    v_mfma_f32_16x16x32_bf16 v[112:115], v[72:75], a[88:91], v[112:115]
    ds_read_b64_tr_b16 v[88:89], v29 offset:57344
    v_lshl_add_u32 v190, v191, 6, v190
    v_mfma_f32_16x16x32_bf16 v[120:123], v[72:75], a[92:95], v[120:123]
    ds_read_b64_tr_b16 v[90:91], v29 offset:57856
    s_lshr_b32 s84, s82, 2
    s_waitcnt lgkmcnt(4)
    v_mfma_f32_16x16x32_bf16 v[128:131], v[76:79], a[80:83], v[128:131]
    s_lshl_b32 s84, s84, 1
    s_add_u32 s84, s84, s50
    v_mfma_f32_16x16x32_bf16 v[136:139], v[76:79], a[84:87], v[136:139]
    s_lshl_b32 s84, s84, 4
    s_and_b32 s85, s82, 3
    v_mfma_f32_16x16x32_bf16 v[144:147], v[76:79], a[88:91], v[144:147]
    v_add_u32 v29, 0x10000, v29
    s_add_u32 s84, s84, s85
    v_mfma_f32_16x16x32_bf16 v[152:155], v[76:79], a[92:95], v[152:155]
    s_add_u32 s84, s84, 4096
    v_lshl_add_u32 v190, v190, 2, s84
    s_waitcnt lgkmcnt(2)
    v_mfma_f32_16x16x32_bf16 v[100:103], v[84:87], a[80:83], v[100:103]
    ds_read_b64_tr_b16 v[72:73], v26 offset:0
    v_lshlrev_b32 v24, 7, v190
    v_mfma_f32_16x16x32_bf16 v[108:111], v[84:87], a[84:87], v[108:111]
    ds_read_b64_tr_b16 v[74:75], v26 offset:512
    v_mfma_f32_16x16x32_bf16 v[116:119], v[84:87], a[88:91], v[116:119]
    ds_read_b64_tr_b16 v[76:77], v26 offset:8192
    v_mfma_f32_16x16x32_bf16 v[124:127], v[84:87], a[92:95], v[124:127]
    ds_read_b64_tr_b16 v[78:79], v26 offset:8704
    s_waitcnt lgkmcnt(4)
    v_mfma_f32_16x16x32_bf16 v[132:135], v[88:91], a[80:83], v[132:135]
    v_mfma_f32_16x16x32_bf16 v[140:143], v[88:91], a[84:87], v[140:143]
    v_mfma_f32_16x16x32_bf16 v[148:151], v[88:91], a[88:91], v[148:151]
    v_mfma_f32_16x16x32_bf16 v[156:159], v[88:91], a[92:95], v[156:159]
    s_waitcnt lgkmcnt(2)
    v_mfma_f32_16x16x32_bf16 v[96:99], v[72:75], a[96:99], v[96:99]
    ds_read_b64_tr_b16 v[84:85], v27 offset:0
    s_lshr_b32 s62, s2, 3
    v_mfma_f32_16x16x32_bf16 v[104:107], v[72:75], a[100:103], v[104:107]
    ds_read_b64_tr_b16 v[86:87], v27 offset:512
    s_lshl2_add_u32 s62, s62, s48
    v_mfma_f32_16x16x32_bf16 v[112:115], v[72:75], a[104:107], v[112:115]
    ds_read_b64_tr_b16 v[88:89], v27 offset:8192
    v_mov_b32 v35, 0x40000000
    v_mfma_f32_16x16x32_bf16 v[120:123], v[72:75], a[108:111], v[120:123]
    ds_read_b64_tr_b16 v[90:91], v27 offset:8704
    v_mad_u32_u24 v2, s62, 14, v0
    v_mfma_f32_16x16x32_bf16 v[44:47], v[72:75], v[36:39], v[44:47]
    v_cmp_gt_u32 vcc, 14, v0
    v_lshlrev_b32 v2, 10, v2
    s_waitcnt lgkmcnt(4)
    v_mfma_f32_16x16x32_bf16 v[128:131], v[76:79], a[96:99], v[128:131]
    v_lshl_add_u32 v3, s62, 2, v0
    v_cndmask_b32 v2, v35, v2, vcc
    v_mfma_f32_16x16x32_bf16 v[136:139], v[76:79], a[100:103], v[136:139]
    v_cmp_gt_u32 vcc, 4, v0
    v_lshlrev_b32 v3, 10, v3
    v_mfma_f32_16x16x32_bf16 v[144:147], v[76:79], a[104:107], v[144:147]
    buffer_load_dword v2, v2, s[32:35], 0 offen offset:384
    v_cndmask_b32 v3, v35, v3, vcc
    v_mfma_f32_16x16x32_bf16 v[152:155], v[76:79], a[108:111], v[152:155]
    buffer_load_dword v3, v3, s[36:39], 0 offen offset:384
    v_mfma_f32_16x16x32_bf16 v[48:51], v[76:79], v[36:39], v[48:51]
    s_waitcnt lgkmcnt(2)
    v_mfma_f32_16x16x32_bf16 v[100:103], v[84:87], a[96:99], v[100:103]
    ds_read_b64_tr_b16 v[72:73], v28 offset:0
    v_mov_b32 v188, s60
    v_mfma_f32_16x16x32_bf16 v[108:111], v[84:87], a[100:103], v[108:111]
    ds_read_b64_tr_b16 v[74:75], v28 offset:512
    v_mov_b32 v189, s61
    v_mfma_f32_16x16x32_bf16 v[116:119], v[84:87], a[104:107], v[116:119]
    ds_read_b64_tr_b16 v[76:77], v28 offset:8192
    s_add_u32 s44, s44, 0x20000
    s_waitcnt vmcnt(10)
    v_mfma_f32_16x16x32_bf16 v[124:127], v[84:87], a[108:111], v[124:127]
    ds_read_b64_tr_b16 v[78:79], v28 offset:8704
    buffer_store_dwordx2 v[188:189], v17, s[28:31], s44 offen sc1
    v_mfma_f32_16x16x32_bf16 v[44:47], v[84:87], v[40:43], v[44:47]
    s_waitcnt lgkmcnt(4)
    v_mfma_f32_16x16x32_bf16 v[132:135], v[88:91], a[96:99], v[132:135]
    v_mfma_f32_16x16x32_bf16 v[140:143], v[88:91], a[100:103], v[140:143]
    v_mfma_f32_16x16x32_bf16 v[148:151], v[88:91], a[104:107], v[148:151]
    v_mfma_f32_16x16x32_bf16 v[156:159], v[88:91], a[108:111], v[156:159]
    v_mfma_f32_16x16x32_bf16 v[48:51], v[88:91], v[40:43], v[48:51]
    s_waitcnt lgkmcnt(2)
    v_mfma_f32_16x16x32_bf16 v[96:99], v[72:75], a[112:115], v[96:99]
    ds_read_b64_tr_b16 v[84:85], v29 offset:0
    s_cmp_eq_u32 s83, 0
    s_cselect_b32 s86, 0xff800000, 0
    v_mfma_f32_16x16x32_bf16 v[104:107], v[72:75], a[116:119], v[104:107]
    ds_read_b64_tr_b16 v[86:87], v29 offset:512
    s_mov_b32 s87, s86
    v_mfma_f32_16x16x32_bf16 v[112:115], v[72:75], a[120:123], v[112:115]
    ds_read_b64_tr_b16 v[88:89], v29 offset:8192
    v_mov_b64 v[240:241], s[86:87]
    v_mfma_f32_16x16x32_bf16 v[120:123], v[72:75], a[124:127], v[120:123]
    ds_read_b64_tr_b16 v[90:91], v29 offset:8704
    v_mov_b64 v[242:243], s[86:87]
    s_waitcnt lgkmcnt(4)
    v_mfma_f32_16x16x32_bf16 v[128:131], v[76:79], a[112:115], v[128:131]
    v_mov_b64 v[244:245], s[86:87]
    v_mov_b64 v[246:247], s[86:87]
    v_mfma_f32_16x16x32_bf16 v[136:139], v[76:79], a[116:119], v[136:139]
    v_mov_b64 v[248:249], s[86:87]
    v_mov_b64 v[250:251], s[86:87]
    v_mfma_f32_16x16x32_bf16 v[144:147], v[76:79], a[120:123], v[144:147]
    v_mov_b64 v[252:253], s[86:87]
    v_mov_b64 v[254:255], s[86:87]
    v_mfma_f32_16x16x32_bf16 v[152:155], v[76:79], a[124:127], v[152:155]
    s_waitcnt lgkmcnt(0)
    s_barrier
    v_mfma_f32_16x16x32_bf16 v[100:103], v[84:87], a[112:115], v[100:103]
    ds_read_b64_tr_b16 v[72:73], v26 offset:16384
    s_add_u32 m0, s79, 32768
    v_mfma_f32_16x16x32_bf16 v[108:111], v[84:87], a[116:119], v[108:111]
    ds_read_b64_tr_b16 v[74:75], v26 offset:16896
    buffer_load_dwordx4 v13, s[32:35], s45 offen offset:0 lds
    v_mfma_f32_16x16x32_bf16 v[116:119], v[84:87], a[120:123], v[116:119]
    ds_read_b64_tr_b16 v[76:77], v26 offset:24576
    buffer_load_dwordx4 v14, s[32:35], s45 offen offset:1024 lds
    v_mfma_f32_16x16x32_bf16 v[124:127], v[84:87], a[124:127], v[124:127]
    ds_read_b64_tr_b16 v[78:79], v26 offset:25088
    v_add_u32 v20, 98304, v18
    v_mfma_f32_16x16x32_bf16 v[132:135], v[88:91], a[112:115], v[132:135]
    v_add_u32 v21, 98304, v19
    s_lshl_b32 s84, s48, 1
    v_mfma_f32_16x16x32_bf16 v[140:143], v[88:91], a[116:119], v[140:143]
    s_sub_u32 s57, 8, s84
    s_lshl3_add_u32 s84, s83, s84
    v_mfma_f32_16x16x32_bf16 v[148:151], v[88:91], a[120:123], v[148:151]
    buffer_load_dwordx4 v15, s[32:35], s45 offen offset:2048 lds
    s_lshl_b32 s56, s84, 5
    v_mfma_f32_16x16x32_bf16 v[156:159], v[88:91], a[124:127], v[156:159]
    s_add_u32 s56, s56, s82
    s_lshl_b32 s56, s56, 10
    s_waitcnt lgkmcnt(2)
    v_mfma_f32_16x16x32_bf16 v[96:99], v[72:75], a[128:131], v[96:99]
    ds_read_b64_tr_b16 v[84:85], v27 offset:16384
    s_add_u32 s56, s56, 7340032
    v_mfma_f32_16x16x32_bf16 v[104:107], v[72:75], a[132:135], v[104:107]
    ds_read_b64_tr_b16 v[86:87], v27 offset:16896
    buffer_load_dwordx4 v16, s[32:35], s45 offen offset:3072 lds
    v_mfma_f32_16x16x32_bf16 v[112:115], v[72:75], a[136:139], v[112:115]
    ds_read_b64_tr_b16 v[88:89], v27 offset:24576
    s_add_u32 s45, s45, 32768
    v_mfma_f32_16x16x32_bf16 v[120:123], v[72:75], a[140:143], v[120:123]
    ds_read_b64_tr_b16 v[90:91], v27 offset:25088
    s_add_u32 m0, s79, 0
    v_mfma_f32_16x16x32_bf16 v[44:47], v[72:75], v[36:39], v[44:47]
    s_lshl_b32 s53, s82, 6
    s_add_u32 s51, s53, s84
    s_waitcnt lgkmcnt(4)
    v_mfma_f32_16x16x32_bf16 v[128:131], v[76:79], a[128:131], v[128:131]
    s_lshl_b32 s51, s51, 10
    s_add_u32 s51, s51, 1048576
    v_mfma_f32_16x16x32_bf16 v[136:139], v[76:79], a[132:135], v[136:139]
    buffer_load_dwordx4 v13, s[32:35], s45 offen offset:0 lds
    s_lshl1_add_u32 s84, s83, s48
    v_mfma_f32_16x16x32_bf16 v[144:147], v[76:79], a[136:139], v[144:147]
    s_sub_u32 s84, s84, 2
    s_max_i32 s84, s84, 0
    v_mfma_f32_16x16x32_bf16 v[152:155], v[76:79], a[140:143], v[152:155]
    s_lshl2_add_u32 s53, s84, s53
    s_lshl_b32 s53, s53, 10
    v_mfma_f32_16x16x32_bf16 v[48:51], v[76:79], v[36:39], v[48:51]
    s_add_u32 s52, s53, 3145728
    s_add_u32 s53, s53, 5242880
    s_waitcnt lgkmcnt(2)
    v_mfma_f32_16x16x32_bf16 v[100:103], v[84:87], a[128:131], v[100:103]
    ds_read_b64_tr_b16 v[72:73], v28 offset:16384
    buffer_load_dwordx4 v14, s[32:35], s45 offen offset:1024 lds
    v_mfma_f32_16x16x32_bf16 v[108:111], v[84:87], a[132:135], v[108:111]
    ds_read_b64_tr_b16 v[74:75], v28 offset:16896
    s_lshl1_add_u32 s84, s82, s49
    v_mfma_f32_16x16x32_bf16 v[116:119], v[84:87], a[136:139], v[116:119]
    ds_read_b64_tr_b16 v[76:77], v28 offset:24576
    s_xor_b32 s85, s84, 1
    v_mfma_f32_16x16x32_bf16 v[124:127], v[84:87], a[140:143], v[124:127]
    ds_read_b64_tr_b16 v[78:79], v28 offset:25088
    buffer_load_dwordx4 v15, s[32:35], s45 offen offset:2048 lds
    v_mfma_f32_16x16x32_bf16 v[44:47], v[84:87], v[40:43], v[44:47]
    s_mul_i32 s58, s84, 114688
    s_mul_i32 s54, s85, 114688
    s_waitcnt lgkmcnt(4)
    v_mfma_f32_16x16x32_bf16 v[132:135], v[88:91], a[128:131], v[132:135]
    s_mul_i32 s85, s48, 12288
    s_add_u32 s85, s85, 9437184
    v_mfma_f32_16x16x32_bf16 v[140:143], v[88:91], a[132:135], v[140:143]
    s_add_u32 s58, s58, s85
    s_add_u32 s54, s54, s85
    v_mfma_f32_16x16x32_bf16 v[148:151], v[88:91], a[136:139], v[148:151]
    s_lshl_b32 s85, s48, 12
    s_add_u32 s85, s85, 49152
    v_mfma_f32_16x16x32_bf16 v[156:159], v[88:91], a[140:143], v[156:159]
    buffer_load_dwordx4 v16, s[32:35], s45 offen offset:3072 lds
    s_add_u32 s45, s45, 32768
    v_mfma_f32_16x16x32_bf16 v[48:51], v[88:91], v[40:43], v[48:51]
    s_add_u32 m0, s79, 16384
    s_add_u32 s65, s58, s85
    s_waitcnt lgkmcnt(2)
    v_mfma_f32_16x16x32_bf16 v[96:99], v[72:75], a[144:147], v[96:99]
    ds_read_b64_tr_b16 v[84:85], v29 offset:16384
    s_add_u32 s66, s54, s85
    v_mfma_f32_16x16x32_bf16 v[104:107], v[72:75], a[148:151], v[104:107]
    ds_read_b64_tr_b16 v[86:87], v29 offset:16896
    buffer_load_dwordx4 v13, s[32:35], s45 offen offset:0 lds
    v_mfma_f32_16x16x32_bf16 v[112:115], v[72:75], a[152:155], v[112:115]
    ds_read_b64_tr_b16 v[88:89], v29 offset:24576
    s_lshl1_add_u32 s78, s84, s50
    v_mfma_f32_16x16x32_bf16 v[120:123], v[72:75], a[156:159], v[120:123]
    ds_read_b64_tr_b16 v[90:91], v29 offset:25088
    s_lshl_b32 s78, s78, 14
    s_waitcnt lgkmcnt(4)
    v_mfma_f32_16x16x32_bf16 v[128:131], v[76:79], a[144:147], v[128:131]
    s_add_u32 s78, s78, 7340032
    s_lshl_b32 s64, s84, 9
    v_mfma_f32_16x16x32_bf16 v[136:139], v[76:79], a[148:151], v[136:139]
    s_add_u32 s64, s64, 65536
    s_lshl_b32 s63, s84, 15
    v_mfma_f32_16x16x32_bf16 v[144:147], v[76:79], a[152:155], v[144:147]
    buffer_load_dwordx4 v14, s[32:35], s45 offen offset:1024 lds
    s_xor_b32 s84, s83, 0
    v_mfma_f32_16x16x32_bf16 v[152:155], v[76:79], a[156:159], v[152:155]
    s_lshl1_add_u32 s84, s84, s50
    s_lshl_b32 s84, s84, 6
    s_waitcnt lgkmcnt(2)
    v_mfma_f32_16x16x32_bf16 v[100:103], v[84:87], a[144:147], v[100:103]
    ds_read_b64_tr_b16 v[72:73], v26 offset:32768
    s_add_u32 s63, s63, s84
    v_mfma_f32_16x16x32_bf16 v[108:111], v[84:87], a[148:151], v[108:111]
    ds_read_b64_tr_b16 v[74:75], v26 offset:33280
    buffer_load_dwordx4 v15, s[32:35], s45 offen offset:2048 lds
    v_mfma_f32_16x16x32_bf16 v[116:119], v[84:87], a[152:155], v[116:119]
    ds_read_b64_tr_b16 v[76:77], v26 offset:40960
    v_and_b32 v12, 15, v0
    v_mfma_f32_16x16x32_bf16 v[124:127], v[84:87], a[156:159], v[124:127]
    ds_read_b64_tr_b16 v[78:79], v26 offset:41472
    v_lshrrev_b32 v11, 5, v0
    s_waitcnt lgkmcnt(4)
    v_mfma_f32_16x16x32_bf16 v[132:135], v[88:91], a[144:147], v[132:135]
    v_lshlrev_b32 v12, 10, v12
    v_lshl_add_u32 v12, v11, 4, v12
    v_mfma_f32_16x16x32_bf16 v[140:143], v[88:91], a[148:151], v[140:143]
    v_and_b32 v11, 16, v0
    v_lshl_add_u32 v12, v11, 1, v12
    v_mfma_f32_16x16x32_bf16 v[148:151], v[88:91], a[152:155], v[148:151]
    v_add_u32 v26, 0x10000, v26
    v_mfma_f32_16x16x32_bf16 v[156:159], v[88:91], a[156:159], v[156:159]
    buffer_load_dwordx4 v16, s[32:35], s45 offen offset:3072 lds
    s_add_u32 s45, s45, 32768
    s_waitcnt lgkmcnt(2)
    v_mfma_f32_16x16x32_bf16 v[96:99], v[72:75], a[160:163], v[96:99]
    ds_read_b64_tr_b16 v[84:85], v27 offset:32768
    s_add_u32 m0, s79, 49152
    v_mfma_f32_16x16x32_bf16 v[104:107], v[72:75], a[164:167], v[104:107]
    ds_read_b64_tr_b16 v[86:87], v27 offset:33280
    buffer_load_dwordx4 v13, s[32:35], s45 offen offset:0 lds
    v_mfma_f32_16x16x32_bf16 v[112:115], v[72:75], a[168:171], v[112:115]
    ds_read_b64_tr_b16 v[88:89], v27 offset:40960
    v_lshrrev_b32 v208, 5, v0
    v_mfma_f32_16x16x32_bf16 v[120:123], v[72:75], a[172:175], v[120:123]
    ds_read_b64_tr_b16 v[90:91], v27 offset:41472
    v_and_b32 v209, 15, v0
    v_mfma_f32_16x16x32_bf16 v[44:47], v[72:75], v[36:39], v[44:47]
    v_lshlrev_b32 v209, 3, v209
    v_lshl_add_u32 v209, v208, 7, v209
    s_waitcnt lgkmcnt(4)
    v_mfma_f32_16x16x32_bf16 v[128:131], v[76:79], a[160:163], v[128:131]
    s_lshl_b32 s84, s48, 11
    s_add_u32 s84, s84, 65536
    v_mfma_f32_16x16x32_bf16 v[136:139], v[76:79], a[164:167], v[136:139]
    v_add_u32 v27, 0x10000, v27
    v_add_u32 v210, s84, v209
    v_mfma_f32_16x16x32_bf16 v[144:147], v[76:79], a[168:171], v[144:147]
    buffer_load_dwordx4 v14, s[32:35], s45 offen offset:1024 lds
    v_add_u32 v170, s84, v1
    v_mfma_f32_16x16x32_bf16 v[152:155], v[76:79], a[172:175], v[152:155]
    v_add_u32 v170, 16384, v170
    s_add_u32 s84, s79, 114688
    v_mfma_f32_16x16x32_bf16 v[48:51], v[76:79], v[36:39], v[48:51]
    v_xor_b32 v209, 128, v209
    v_add_u32 v209, s84, v209
    s_waitcnt lgkmcnt(2)
    v_mfma_f32_16x16x32_bf16 v[100:103], v[84:87], a[160:163], v[100:103]
    ds_read_b64_tr_b16 v[72:73], v28 offset:32768
    buffer_load_dwordx2 v[190:191], v22, s[28:31], 0 offen sc1
    v_mfma_f32_16x16x32_bf16 v[108:111], v[84:87], a[164:167], v[108:111]
    ds_read_b64_tr_b16 v[74:75], v28 offset:33280
    buffer_load_dwordx4 v15, s[32:35], s45 offen offset:2048 lds
    v_mfma_f32_16x16x32_bf16 v[116:119], v[84:87], a[168:171], v[116:119]
    ds_read_b64_tr_b16 v[76:77], v28 offset:40960
    v_add_u32 v211, s84, v1
    v_mfma_f32_16x16x32_bf16 v[124:127], v[84:87], a[172:175], v[124:127]
    ds_read_b64_tr_b16 v[78:79], v28 offset:41472
    buffer_load_dwordx4 v16, s[32:35], s45 offen offset:3072 lds
    s_waitcnt vmcnt(13)
    v_mfma_f32_16x16x32_bf16 v[44:47], v[84:87], v[40:43], v[44:47]
    ds_read_b64_tr_b16 a[0:1], v18 offset:32768
    ds_read_b64_tr_b16 a[2:3], v18 offset:33792
    s_waitcnt lgkmcnt(6)
    v_mfma_f32_16x16x32_bf16 v[132:135], v[88:91], a[160:163], v[132:135]
    ds_read_b64_tr_b16 a[4:5], v19 offset:32768
    ds_read_b64_tr_b16 a[6:7], v19 offset:33792
    v_mfma_f32_16x16x32_bf16 v[140:143], v[88:91], a[164:167], v[140:143]
    v_add_u32 v28, 0x10000, v28
    v_and_b32 v176, 16, v0
    v_mfma_f32_16x16x32_bf16 v[148:151], v[88:91], a[168:171], v[148:151]
    ds_read_b64_tr_b16 a[8:9], v18 offset:34816
    ds_read_b64_tr_b16 a[10:11], v18 offset:35840
    v_mfma_f32_16x16x32_bf16 v[156:159], v[88:91], a[172:175], v[156:159]
    ds_read_b64_tr_b16 a[12:13], v19 offset:34816
    ds_read_b64_tr_b16 a[14:15], v19 offset:35840
    s_waitcnt vmcnt(9)
    v_mfma_f32_16x16x32_bf16 v[48:51], v[88:91], v[40:43], v[48:51]
    ds_read_b64_tr_b16 a[16:17], v18 offset:0
    ds_read_b64_tr_b16 a[18:19], v18 offset:1024
    s_waitcnt lgkmcnt(12)
    v_mfma_f32_16x16x32_bf16 v[96:99], v[72:75], a[176:179], v[96:99]
    ds_read_b64_tr_b16 v[84:85], v29 offset:32768
    ds_read_b64_tr_b16 a[20:21], v19 offset:0
    v_mfma_f32_16x16x32_bf16 v[104:107], v[72:75], a[180:183], v[104:107]
    ds_read_b64_tr_b16 v[86:87], v29 offset:33280
    s_waitcnt lgkmcnt(8)
    ds_read_b64_tr_b16 a[22:23], v19 offset:1024
    v_mfma_f32_16x16x32_bf16 v[112:115], v[72:75], a[184:187], v[112:115]
    ds_read_b64_tr_b16 v[88:89], v29 offset:40960
    ds_read_b64_tr_b16 a[24:25], v18 offset:2048
    v_mfma_f32_16x16x32_bf16 v[120:123], v[72:75], a[188:191], v[120:123]
    ds_read_b64_tr_b16 v[90:91], v29 offset:41472
    ds_read_b64_tr_b16 a[26:27], v18 offset:3072
    v_mfma_f32_16x16x32_bf16 v[128:131], v[76:79], a[176:179], v[128:131]
    ds_read_b64_tr_b16 a[28:29], v19 offset:2048
    ds_read_b64_tr_b16 a[30:31], v19 offset:3072
    v_mfma_f32_16x16x32_bf16 v[136:139], v[76:79], a[180:183], v[136:139]
    v_cmp_eq_u32 s[86:87], 0, v176
    v_mov_b32 v177, 1024
    v_mfma_f32_16x16x32_bf16 v[144:147], v[76:79], a[184:187], v[144:147]
    v_add_u32 v29, 0x10000, v29
    v_and_b32 v176, 31, v0
    v_mfma_f32_16x16x32_bf16 v[152:155], v[76:79], a[188:191], v[152:155]
    v_cndmask_b32 v160, v209, v210, s[86:87]
    v_cndmask_b32 v210, 0, v177, s[86:87]
    s_waitcnt lgkmcnt(0)
    s_barrier
    v_mfma_f32_16x16x32_bf16 v[100:103], v[84:87], a[176:179], v[100:103]
    ds_read_b64_tr_b16 v[72:73], v26 offset:0
    v_lshlrev_b32 v208, 2, v208
    v_mfma_f32_16x16x32_bf16 v[108:111], v[84:87], a[180:183], v[108:111]
    ds_read_b64_tr_b16 v[74:75], v26 offset:512
    v_sub_u32 v176, v176, v208
    v_mfma_f32_16x16x32_bf16 v[116:119], v[84:87], a[184:187], v[116:119]
    ds_read_b64_tr_b16 v[76:77], v26 offset:8192
    s_add_u32 s45, s45, 32768
    v_mfma_f32_16x16x32_bf16 v[124:127], v[84:87], a[188:191], v[124:127]
    ds_read_b64_tr_b16 v[78:79], v26 offset:8704
    s_add_u32 m0, s79, 32768
    v_mfma_f32_16x16x32_bf16 v[132:135], v[88:91], a[176:179], v[132:135]
    buffer_load_dwordx4 v13, s[32:35], s45 offen offset:0 lds
    v_mov_b32 v177, 0xffff
    v_mfma_f32_16x16x32_bf16 v[140:143], v[88:91], a[180:183], v[140:143]
    buffer_load_dwordx4 v14, s[32:35], s45 offen offset:1024 lds
    v_mov_b32 v178, 0xff800000
    v_mfma_f32_16x16x32_bf16 v[148:151], v[88:91], a[184:187], v[148:151]
    v_mov_b32 v179, 0xff800000
    v_add_u32 v161, v160, v210
    v_mfma_f32_16x16x32_bf16 v[156:159], v[88:91], a[188:191], v[156:159]
    v_add_u32 v162, v161, v210
    v_add_u32 v163, v162, v210
    s_waitcnt lgkmcnt(2)
    v_mfma_f32_16x16x32_bf16 v[96:99], v[72:75], a[192:195], v[96:99]
    ds_read_b64_tr_b16 v[84:85], v27 offset:0
    buffer_load_dwordx4 v15, s[32:35], s45 offen offset:2048 lds
    v_mfma_f32_16x16x32_bf16 v[104:107], v[72:75], a[196:199], v[104:107]
    ds_read_b64_tr_b16 v[86:87], v27 offset:512
    v_add_u32 v164, v163, v210
    v_mfma_f32_16x16x32_bf16 v[112:115], v[72:75], a[200:203], v[112:115]
    ds_read_b64_tr_b16 v[88:89], v27 offset:8192
    v_add_u32 v165, v164, v210
    v_mfma_f32_16x16x32_bf16 v[120:123], v[72:75], a[204:207], v[120:123]
    ds_read_b64_tr_b16 v[90:91], v27 offset:8704
    v_add_u32 v166, v165, v210
    v_mfma_f32_16x16x32_bf16 v[44:47], v[72:75], v[36:39], v[44:47]
    buffer_load_dwordx4 v16, s[32:35], s45 offen offset:3072 lds
    s_add_u32 s45, s45, 32768
    s_waitcnt lgkmcnt(4)
    v_mfma_f32_16x16x32_bf16 v[128:131], v[76:79], a[192:195], v[128:131]
    s_add_u32 m0, s79, 0
    v_add_u32 v167, v166, v210
    v_mfma_f32_16x16x32_bf16 v[136:139], v[76:79], a[196:199], v[136:139]
    v_add_u32 v168, v167, v210
    v_add_u32 v169, v168, v210
    v_mfma_f32_16x16x32_bf16 v[144:147], v[76:79], a[200:203], v[144:147]
    v_mov_b32 v212, 0x3f803f80
    v_mov_b32 v213, 0x3f803f80
    v_mfma_f32_16x16x32_bf16 v[152:155], v[76:79], a[204:207], v[152:155]
    buffer_load_dwordx4 v13, s[32:35], s45 offen offset:0 lds
    v_mov_b32 v214, 0x3f803f80
    v_mfma_f32_16x16x32_bf16 v[48:51], v[76:79], v[36:39], v[48:51]
    v_mov_b32 v215, 0x3f803f80
    v_lshlrev_b32 v208, v176, 2
    s_waitcnt lgkmcnt(2)
    v_mfma_f32_16x16x32_bf16 v[100:103], v[84:87], a[192:195], v[100:103]
    ds_read_b64_tr_b16 v[72:73], v28 offset:0
    buffer_load_dwordx4 v14, s[32:35], s45 offen offset:1024 lds
    v_mfma_f32_16x16x32_bf16 v[108:111], v[84:87], a[196:199], v[108:111]
    ds_read_b64_tr_b16 v[74:75], v28 offset:512
    buffer_load_dwordx4 v15, s[32:35], s45 offen offset:2048 lds
    v_mfma_f32_16x16x32_bf16 v[116:119], v[84:87], a[200:203], v[116:119]
    ds_read_b64_tr_b16 v[76:77], v28 offset:8192
    buffer_load_dwordx4 v16, s[32:35], s45 offen offset:3072 lds
    s_waitcnt vmcnt(13)
    v_mfma_f32_16x16x32_bf16 v[124:127], v[84:87], a[204:207], v[124:127]
    ds_read_b64_tr_b16 v[78:79], v28 offset:8704
    ds_read_b64_tr_b16 a[32:33], v18 offset:16384
    v_mfma_f32_16x16x32_bf16 v[44:47], v[84:87], v[40:43], v[44:47]
    ds_read_b64_tr_b16 a[34:35], v18 offset:17408
    ds_read_b64_tr_b16 a[36:37], v19 offset:16384
    s_waitcnt lgkmcnt(7)
    v_mfma_f32_16x16x32_bf16 v[132:135], v[88:91], a[192:195], v[132:135]
    ds_read_b64_tr_b16 a[38:39], v19 offset:17408
    ds_read_b64_tr_b16 a[40:41], v18 offset:18432
    v_mfma_f32_16x16x32_bf16 v[140:143], v[88:91], a[196:199], v[140:143]
    ds_read_b64_tr_b16 a[42:43], v18 offset:19456
    ds_read_b64_tr_b16 a[44:45], v19 offset:18432
    v_mfma_f32_16x16x32_bf16 v[148:151], v[88:91], a[200:203], v[148:151]
    ds_read_b64_tr_b16 a[46:47], v19 offset:19456
    s_waitcnt vmcnt(8)
    ds_read_b64_tr_b16 a[48:49], v18 offset:49152
    v_mfma_f32_16x16x32_bf16 v[156:159], v[88:91], a[204:207], v[156:159]
    ds_read_b64_tr_b16 a[50:51], v18 offset:50176
    ds_read_b64_tr_b16 a[52:53], v19 offset:49152
    v_mfma_f32_16x16x32_bf16 v[48:51], v[88:91], v[40:43], v[48:51]
    s_waitcnt lgkmcnt(8)
    ds_read_b64_tr_b16 a[54:55], v19 offset:50176
    ds_read_b64_tr_b16 a[56:57], v18 offset:51200
    v_mfma_f32_16x16x32_bf16 v[96:99], v[72:75], a[208:211], v[96:99]
    ds_read_b64_tr_b16 v[84:85], v29 offset:0
    ds_read_b64_tr_b16 a[58:59], v18 offset:52224
    v_mfma_f32_16x16x32_bf16 v[104:107], v[72:75], a[212:215], v[104:107]
    ds_read_b64_tr_b16 v[86:87], v29 offset:512
    ds_read_b64_tr_b16 a[60:61], v19 offset:51200
    v_mfma_f32_16x16x32_bf16 v[112:115], v[72:75], a[216:219], v[112:115]
    ds_read_b64_tr_b16 v[88:89], v29 offset:8192
    s_waitcnt lgkmcnt(8)
    ds_read_b64_tr_b16 a[62:63], v19 offset:52224
L_qa_chk:
    v_cmp_ne_u64 s[46:47], s[60:61], v[190:191]
    s_cmp_lg_u64 s[46:47], 0
    s_cbranch_scc1 L_qa_retry
L_qa_ok:
    v_mfma_f32_16x16x32_bf16 v[120:123], v[72:75], a[220:223], v[120:123]
    ds_read_b64_tr_b16 v[90:91], v29 offset:8704
    buffer_load_dwordx4 a[128:131], v1, s[28:31], s51 offen offset:0 sc1
    v_mfma_f32_16x16x32_bf16 v[128:131], v[76:79], a[208:211], v[128:131]
    buffer_load_dwordx4 a[132:135], v1, s[28:31], s51 offen offset:1024 sc1
    s_add_u32 m0, s79, 81920
    v_mfma_f32_16x16x32_bf16 v[136:139], v[76:79], a[212:215], v[136:139]
    buffer_load_dwordx4 v1, s[28:31], s52 offen offset:0 sc1 lds
    v_ashrrev_i32 v209, 31, v176
    v_mfma_f32_16x16x32_bf16 v[144:147], v[76:79], a[216:219], v[144:147]
    buffer_load_dwordx4 v1, s[28:31], s52 offen offset:1024 sc1 lds
    v_add_u32 v208, -1, v208
    v_mfma_f32_16x16x32_bf16 v[152:155], v[76:79], a[220:223], v[152:155]
    buffer_load_dwordx4 v1, s[28:31], s52 offen offset:2048 sc1 lds
    v_bfi_b32 v208, v209, 0, v208
    s_waitcnt lgkmcnt(4)
    v_mfma_f32_16x16x32_bf16 v[100:103], v[84:87], a[208:211], v[100:103]
    ds_read_b64_tr_b16 v[72:73], v26 offset:16384
    buffer_load_dwordx4 v1, s[28:31], s52 offen offset:3072 sc1 lds
    v_mfma_f32_16x16x32_bf16 v[108:111], v[84:87], a[212:215], v[108:111]
    ds_read_b64_tr_b16 v[74:75], v26 offset:16896
    s_add_u32 m0, s79, 65536
    v_mfma_f32_16x16x32_bf16 v[116:119], v[84:87], a[216:219], v[116:119]
    ds_read_b64_tr_b16 v[76:77], v26 offset:24576
    v_bfe_i32 v192, v208, 0, 1
    v_mfma_f32_16x16x32_bf16 v[124:127], v[84:87], a[220:223], v[124:127]
    ds_read_b64_tr_b16 v[78:79], v26 offset:25088
    buffer_load_dwordx4 v1, s[28:31], s53 offen offset:0 sc1 lds
    s_waitcnt lgkmcnt(4)
    v_mfma_f32_16x16x32_bf16 v[132:135], v[88:91], a[208:211], v[132:135]
    v_bfe_i32 v193, v208, 1, 1
    v_bfe_i32 v194, v208, 2, 1
    v_mfma_f32_16x16x32_bf16 v[140:143], v[88:91], a[212:215], v[140:143]
    v_bfe_i32 v195, v208, 3, 1
    v_bfe_i32 v196, v208, 8, 1
    v_mfma_f32_16x16x32_bf16 v[148:151], v[88:91], a[216:219], v[148:151]
    v_bfe_i32 v197, v208, 9, 1
    v_bfe_i32 v198, v208, 10, 1
    v_mfma_f32_16x16x32_bf16 v[156:159], v[88:91], a[220:223], v[156:159]
    v_bfe_i32 v199, v208, 11, 1
    v_bfe_i32 v200, v208, 16, 1
    s_waitcnt lgkmcnt(2)
    v_mfma_f32_16x16x32_bf16 v[96:99], v[72:75], a[224:227], v[96:99]
    ds_read_b64_tr_b16 v[84:85], v27 offset:16384
    buffer_load_dwordx4 v1, s[28:31], s53 offen offset:1024 sc1 lds
    v_mfma_f32_16x16x32_bf16 v[104:107], v[72:75], a[228:231], v[104:107]
    ds_read_b64_tr_b16 v[86:87], v27 offset:16896
    v_bfe_i32 v201, v208, 17, 1
    v_mfma_f32_16x16x32_bf16 v[112:115], v[72:75], a[232:235], v[112:115]
    ds_read_b64_tr_b16 v[88:89], v27 offset:24576
    v_bfe_i32 v202, v208, 18, 1
    v_mfma_f32_16x16x32_bf16 v[120:123], v[72:75], a[236:239], v[120:123]
    ds_read_b64_tr_b16 v[90:91], v27 offset:25088
    buffer_load_dwordx4 v1, s[28:31], s53 offen offset:2048 sc1 lds
    v_mfma_f32_16x16x32_bf16 v[44:47], v[72:75], v[36:39], v[44:47]
    v_bfe_i32 v203, v208, 19, 1
    v_bfe_i32 v204, v208, 24, 1
    s_waitcnt lgkmcnt(4)
    v_mfma_f32_16x16x32_bf16 v[128:131], v[76:79], a[224:227], v[128:131]
    v_bfe_i32 v205, v208, 25, 1
    v_bfe_i32 v206, v208, 26, 1
    v_mfma_f32_16x16x32_bf16 v[136:139], v[76:79], a[228:231], v[136:139]
    v_bfe_i32 v207, v208, 27, 1
    v_bfi_b32 v180, v177, v192, v193
    v_mfma_f32_16x16x32_bf16 v[144:147], v[76:79], a[232:235], v[144:147]
    v_bfi_b32 v181, v177, v194, v195
    v_bfi_b32 v182, v177, v196, v197
    v_mfma_f32_16x16x32_bf16 v[152:155], v[76:79], a[236:239], v[152:155]
    buffer_load_dwordx4 v1, s[28:31], s53 offen offset:3072 sc1 lds
    s_lshl_b32 s62, s48, 16
    s_add_u32 s45, s45, s62
    v_mfma_f32_16x16x32_bf16 v[48:51], v[76:79], v[36:39], v[48:51]
    s_add_u32 s45, s45, 622592
    s_add_u32 m0, s79, 16384
    s_waitcnt lgkmcnt(2)
    v_mfma_f32_16x16x32_bf16 v[100:103], v[84:87], a[224:227], v[100:103]
    ds_read_b64_tr_b16 v[72:73], v28 offset:16384
    v_bfi_b32 v183, v177, v198, v199
    v_mfma_f32_16x16x32_bf16 v[108:111], v[84:87], a[228:231], v[108:111]
    ds_read_b64_tr_b16 v[74:75], v28 offset:16896
    buffer_load_dwordx4 v13, s[32:35], s45 offen offset:0 lds
    v_mfma_f32_16x16x32_bf16 v[116:119], v[84:87], a[232:235], v[116:119]
    ds_read_b64_tr_b16 v[76:77], v28 offset:24576
    v_bfi_b32 v184, v177, v200, v201
    v_mfma_f32_16x16x32_bf16 v[124:127], v[84:87], a[236:239], v[124:127]
    ds_read_b64_tr_b16 v[78:79], v28 offset:25088
    v_bfi_b32 v185, v177, v202, v203
    v_mfma_f32_16x16x32_bf16 v[44:47], v[84:87], v[40:43], v[44:47]
    v_bfi_b32 v186, v177, v204, v205
    v_bfi_b32 v187, v177, v206, v207
    s_waitcnt lgkmcnt(4)
    v_mfma_f32_16x16x32_bf16 v[132:135], v[88:91], a[224:227], v[132:135]
    buffer_load_dwordx4 v14, s[32:35], s45 offen offset:1024 lds
    v_and_b32 v10, 31, v0
    v_mfma_f32_16x16x32_bf16 v[140:143], v[88:91], a[228:231], v[140:143]
    v_lshlrev_b32 v10, 4, v10
    s_add_u32 s44, s44, 0x20000
    v_mfma_f32_16x16x32_bf16 v[148:151], v[88:91], a[232:235], v[148:151]
    v_cvt_pk_bf16_f32 v216, v44, v45
    v_cvt_pk_bf16_f32 v217, v46, v47
    v_mfma_f32_16x16x32_bf16 v[156:159], v[88:91], a[236:239], v[156:159]
    v_lshlrev_b32 v218, 16, v216
    v_and_b32 v219, 0xffff0000, v216
    v_mfma_f32_16x16x32_bf16 v[48:51], v[88:91], v[40:43], v[48:51]
    v_lshlrev_b32 v220, 16, v217
    v_and_b32 v221, 0xffff0000, v217
    s_waitcnt lgkmcnt(2)
    v_mfma_f32_16x16x32_bf16 v[96:99], v[72:75], a[240:243], v[96:99]
    ds_read_b64_tr_b16 v[84:85], v29 offset:16384
    v_sub_f32 v218, v44, v218
    v_mfma_f32_16x16x32_bf16 v[104:107], v[72:75], a[244:247], v[104:107]
    ds_read_b64_tr_b16 v[86:87], v29 offset:16896
    v_sub_f32 v219, v45, v219
    v_mfma_f32_16x16x32_bf16 v[112:115], v[72:75], a[248:251], v[112:115]
    ds_read_b64_tr_b16 v[88:89], v29 offset:24576
    v_sub_f32 v220, v46, v220
    v_mfma_f32_16x16x32_bf16 v[120:123], v[72:75], a[252:255], v[120:123]
    ds_read_b64_tr_b16 v[90:91], v29 offset:25088
    v_sub_f32 v221, v47, v221
    s_waitcnt lgkmcnt(4)
    v_mfma_f32_16x16x32_bf16 v[128:131], v[76:79], a[240:243], v[128:131]
    v_cvt_pk_bf16_f32 v222, v218, v219
    v_cvt_pk_bf16_f32 v223, v220, v221
    v_mfma_f32_16x16x32_bf16 v[136:139], v[76:79], a[244:247], v[136:139]
    ds_write_b64 v32, v[216:217] offset:2048
    ds_write_b64 v32, v[222:223] offset:2112
    v_mfma_f32_16x16x32_bf16 v[144:147], v[76:79], a[248:251], v[144:147]
    v_cvt_pk_bf16_f32 v216, v48, v49
    v_cvt_pk_bf16_f32 v217, v50, v51
    v_mfma_f32_16x16x32_bf16 v[152:155], v[76:79], a[252:255], v[152:155]
    v_lshlrev_b32 v218, 16, v216
    v_and_b32 v219, 0xffff0000, v216
    v_lshlrev_b32 v220, 16, v217
    v_and_b32 v221, 0xffff0000, v217
    v_sub_f32 v218, v48, v218
    v_sub_f32 v219, v49, v219
    v_sub_f32 v220, v50, v220
    v_sub_f32 v221, v51, v221
    v_cvt_pk_bf16_f32 v222, v218, v219
    v_cvt_pk_bf16_f32 v223, v220, v221
    ds_write_b64 v32, v[216:217] offset:2560
    ds_write_b64 v32, v[222:223] offset:2624
    s_waitcnt lgkmcnt(0)
    s_barrier
    s_bfe_u32 s84, s2, 0x30003
    s_cmp_eq_u32 s84, 0
    s_cselect_b32 s57, s57, 0
    v_mfma_f32_16x16x32_bf16 v[100:103], v[84:87], a[240:243], v[100:103]
    ds_read_b64_tr_b16 v[64:65], v33 offset:2048
    buffer_load_dwordx4 v15, s[32:35], s45 offen offset:2048 lds
    v_mfma_f32_16x16x32_bf16 v[108:111], v[84:87], a[244:247], v[108:111]
    ds_read_b64_tr_b16 v[66:67], v33 offset:2560
    buffer_load_dwordx4 v16, s[32:35], s45 offen offset:3072 lds
    v_mfma_f32_16x16x32_bf16 v[116:119], v[84:87], a[248:251], v[116:119]
    s_add_u32 s45, s45, 32768
    s_add_u32 m0, s79, 49152
    v_mfma_f32_16x16x32_bf16 v[124:127], v[84:87], a[252:255], v[124:127]
    buffer_load_dwordx4 v13, s[32:35], s45 offen offset:0 lds
    v_mfma_f32_16x16x32_bf16 v[132:135], v[88:91], a[240:243], v[132:135]
    buffer_load_dwordx4 v14, s[32:35], s45 offen offset:1024 lds
    v_mfma_f32_16x16x32_bf16 v[140:143], v[88:91], a[244:247], v[140:143]
    buffer_load_dwordx4 v15, s[32:35], s45 offen offset:2048 lds
    v_mfma_f32_16x16x32_bf16 v[148:151], v[88:91], a[248:251], v[148:151]
    v_mfma_f32_16x16x32_bf16 v[156:159], v[88:91], a[252:255], v[156:159]
    buffer_load_dwordx4 v16, s[32:35], s45 offen offset:3072 lds
    s_waitcnt lgkmcnt(1)
    v_mfma_f32_16x16x4_4b_bf16 v[96:111], v[64:65], v[56:57], v[96:111]
    s_waitcnt lgkmcnt(0)
    v_mfma_f32_16x16x4_4b_bf16 v[128:143], v[66:67], v[56:57], v[128:143]
    v_mfma_f32_16x16x4_4b_bf16 v[112:127], v[64:65], v[60:61], v[112:127]
    buffer_load_dwordx4 v[2:5], v12, s[4:7], s63 offen
    s_add_u32 s62, s63, 16384
    buffer_load_dwordx4 v[6:9], v12, s[4:7], s62 offen
    v_mfma_f32_16x16x4_4b_bf16 v[144:159], v[66:67], v[60:61], v[144:159]
    s_nop 5
    s_branch L_p2done
L_p2b:
    s_waitcnt lgkmcnt(2)
    v_mfma_f32_16x16x32_bf16 v[96:99], v[72:75], a[0:3], 0
    ds_read_b64_tr_b16 v[84:85], v27 offset:0
    s_cmp_ge_u32 s67, 16
    s_cselect_b64 vcc, -1, 0
    v_cndmask_b32 v10, v30, v34, vcc
    v_mfma_f32_16x16x32_bf16 v[104:107], v[72:75], a[4:7], 0
    ds_read_b64_tr_b16 v[86:87], v27 offset:512
    s_cmp_ge_u32 s67, 15
    s_cselect_b64 vcc, -1, 0
    v_cndmask_b32 v11, v30, v34, vcc
    v_mfma_f32_16x16x32_bf16 v[112:115], v[72:75], a[8:11], 0
    ds_read_b64_tr_b16 v[88:89], v27 offset:8192
    s_cmp_ge_u32 s67, 14
    s_cselect_b64 vcc, -1, 0
    v_cndmask_b32 v12, v30, v34, vcc
    v_mfma_f32_16x16x32_bf16 v[120:123], v[72:75], a[12:15], 0
    ds_read_b64_tr_b16 v[90:91], v27 offset:8704
    v_mul_f32 v160, v58, v160
    v_mul_f32 v161, v58, v161
    v_mul_f32 v162, v58, v162
    v_mfma_f32_16x16x32_bf16 v[44:47], v[72:75], v[36:39], 0
    v_mul_f32 v163, v58, v163
    v_mul_f32 v164, v58, v164
    v_mul_f32 v165, v58, v165
    v_mul_f32 v166, v58, v166
    s_waitcnt lgkmcnt(4)
    v_mfma_f32_16x16x32_bf16 v[128:131], v[76:79], a[0:3], 0
    v_mul_f32 v167, v58, v167
    v_mul_f32 v168, v59, v168
    v_mul_f32 v169, v59, v169
    v_mul_f32 v170, v59, v170
    v_mfma_f32_16x16x32_bf16 v[136:139], v[76:79], a[4:7], 0
    v_mul_f32 v171, v59, v171
    v_mul_f32 v172, v59, v172
    v_mul_f32 v173, v59, v173
    v_mul_f32 v174, v59, v174
    s_waitcnt vmcnt(8)
    v_mfma_f32_16x16x32_bf16 v[144:147], v[76:79], a[8:11], 0
    v_mul_f32 v175, v59, v175
    v_cvt_pk_bf16_f32 v160, v160, v161
    v_cvt_pk_bf16_f32 v161, v162, v163
    v_cvt_pk_bf16_f32 v162, v164, v165
    v_mfma_f32_16x16x32_bf16 v[152:155], v[76:79], a[12:15], 0
    v_cvt_pk_bf16_f32 v163, v166, v167
    v_mfma_f32_16x16x32_bf16 v[48:51], v[76:79], v[36:39], 0
    buffer_store_dwordx4 v[160:163], v10, s[28:31], s68 offen offset:0 sc1
    v_cvt_pk_bf16_f32 v168, v168, v169
    v_cvt_pk_bf16_f32 v169, v170, v171
    v_cvt_pk_bf16_f32 v170, v172, v173
    s_waitcnt lgkmcnt(2)
    v_mfma_f32_16x16x32_bf16 v[100:103], v[84:87], a[0:3], 0
    ds_read_b64_tr_b16 v[72:73], v28 offset:0
    v_cvt_pk_bf16_f32 v171, v174, v175
    v_mfma_f32_16x16x32_bf16 v[108:111], v[84:87], a[4:7], 0
    ds_read_b64_tr_b16 v[74:75], v28 offset:512
    buffer_store_dwordx4 v[168:171], v10, s[28:31], s69 offen offset:0 sc1
    v_mul_f32 v176, v62, v176
    v_mul_f32 v177, v62, v177
    v_mfma_f32_16x16x32_bf16 v[116:119], v[84:87], a[8:11], 0
    ds_read_b64_tr_b16 v[76:77], v28 offset:8192
    v_mul_f32 v178, v62, v178
    v_mul_f32 v179, v62, v179
    v_mul_f32 v180, v62, v180
    v_mfma_f32_16x16x32_bf16 v[124:127], v[84:87], a[12:15], 0
    ds_read_b64_tr_b16 v[78:79], v28 offset:8704
    v_mul_f32 v181, v62, v181
    v_mul_f32 v182, v62, v182
    v_mul_f32 v183, v62, v183
    v_mfma_f32_16x16x32_bf16 v[44:47], v[84:87], v[40:43], v[44:47]
    v_mul_f32 v184, v63, v184
    v_mul_f32 v185, v63, v185
    v_mul_f32 v186, v63, v186
    v_mul_f32 v187, v63, v187
    s_waitcnt lgkmcnt(4)
    v_mfma_f32_16x16x32_bf16 v[132:135], v[88:91], a[0:3], 0
    v_mul_f32 v188, v63, v188
    v_mul_f32 v189, v63, v189
    v_mul_f32 v190, v63, v190
    v_mul_f32 v191, v63, v191
    v_mfma_f32_16x16x32_bf16 v[140:143], v[88:91], a[4:7], 0
    v_cvt_pk_bf16_f32 v176, v176, v177
    v_cvt_pk_bf16_f32 v177, v178, v179
    v_cvt_pk_bf16_f32 v178, v180, v181
    v_cvt_pk_bf16_f32 v179, v182, v183
    v_mfma_f32_16x16x32_bf16 v[148:151], v[88:91], a[8:11], 0
    buffer_store_dwordx4 v[176:179], v10, s[28:31], s68 offen offset:1024 sc1
    v_cvt_pk_bf16_f32 v184, v184, v185
    v_cvt_pk_bf16_f32 v185, v186, v187
    v_cvt_pk_bf16_f32 v186, v188, v189
    v_mfma_f32_16x16x32_bf16 v[156:159], v[88:91], a[12:15], 0
    v_cvt_pk_bf16_f32 v187, v190, v191
    v_mfma_f32_16x16x32_bf16 v[48:51], v[88:91], v[40:43], v[48:51]
    buffer_store_dwordx4 v[184:187], v10, s[28:31], s69 offen offset:1024 sc1
    v_mul_f32 v192, v58, v192
    v_mul_f32 v193, v58, v193
    v_mul_f32 v194, v58, v194
    s_waitcnt lgkmcnt(2)
    v_mfma_f32_16x16x32_bf16 v[96:99], v[72:75], a[16:19], v[96:99]
    ds_read_b64_tr_b16 v[84:85], v29 offset:0
    v_mul_f32 v195, v58, v195
    v_mul_f32 v196, v58, v196
    v_mul_f32 v197, v58, v197
    v_mfma_f32_16x16x32_bf16 v[104:107], v[72:75], a[20:23], v[104:107]
    ds_read_b64_tr_b16 v[86:87], v29 offset:512
    v_mul_f32 v198, v58, v198
    v_mul_f32 v199, v58, v199
    v_mul_f32 v200, v59, v200
    v_mfma_f32_16x16x32_bf16 v[112:115], v[72:75], a[24:27], v[112:115]
    ds_read_b64_tr_b16 v[88:89], v29 offset:8192
    v_mul_f32 v201, v59, v201
    v_mul_f32 v202, v59, v202
    v_mul_f32 v203, v59, v203
    v_mfma_f32_16x16x32_bf16 v[120:123], v[72:75], a[28:31], v[120:123]
    ds_read_b64_tr_b16 v[90:91], v29 offset:8704
    v_mul_f32 v204, v59, v204
    v_mul_f32 v205, v59, v205
    v_mul_f32 v206, v59, v206
    s_waitcnt lgkmcnt(4)
    v_mfma_f32_16x16x32_bf16 v[128:131], v[76:79], a[16:19], v[128:131]
    v_mul_f32 v207, v59, v207
    v_cvt_pk_bf16_f32 v192, v192, v193
    v_cvt_pk_bf16_f32 v193, v194, v195
    v_cvt_pk_bf16_f32 v194, v196, v197
    v_mfma_f32_16x16x32_bf16 v[136:139], v[76:79], a[20:23], v[136:139]
    v_cvt_pk_bf16_f32 v195, v198, v199
    v_mfma_f32_16x16x32_bf16 v[144:147], v[76:79], a[24:27], v[144:147]
    buffer_store_dwordx4 v[192:195], v11, s[28:31], s70 offen offset:0 sc1
    v_cvt_pk_bf16_f32 v200, v200, v201
    v_cvt_pk_bf16_f32 v201, v202, v203
    v_cvt_pk_bf16_f32 v202, v204, v205
    v_mfma_f32_16x16x32_bf16 v[152:155], v[76:79], a[28:31], v[152:155]
    v_cvt_pk_bf16_f32 v203, v206, v207
    s_waitcnt lgkmcnt(2)
    v_mfma_f32_16x16x32_bf16 v[100:103], v[84:87], a[16:19], v[100:103]
    ds_read_b64_tr_b16 v[72:73], v26 offset:16384
    buffer_store_dwordx4 v[200:203], v11, s[28:31], s71 offen offset:0 sc1
    v_mul_f32 v208, v62, v208
    v_mul_f32 v209, v62, v209
    v_mfma_f32_16x16x32_bf16 v[108:111], v[84:87], a[20:23], v[108:111]
    ds_read_b64_tr_b16 v[74:75], v26 offset:16896
    v_mul_f32 v210, v62, v210
    v_mul_f32 v211, v62, v211
    v_mul_f32 v212, v62, v212
    v_mfma_f32_16x16x32_bf16 v[116:119], v[84:87], a[24:27], v[116:119]
    ds_read_b64_tr_b16 v[76:77], v26 offset:24576
    v_mul_f32 v213, v62, v213
    v_mul_f32 v214, v62, v214
    v_mul_f32 v215, v62, v215
    v_mfma_f32_16x16x32_bf16 v[124:127], v[84:87], a[28:31], v[124:127]
    ds_read_b64_tr_b16 v[78:79], v26 offset:25088
    v_mul_f32 v216, v63, v216
    v_mul_f32 v217, v63, v217
    v_mul_f32 v218, v63, v218
    s_waitcnt lgkmcnt(4)
    v_mfma_f32_16x16x32_bf16 v[132:135], v[88:91], a[16:19], v[132:135]
    v_mul_f32 v219, v63, v219
    v_mul_f32 v220, v63, v220
    v_mul_f32 v221, v63, v221
    v_mul_f32 v222, v63, v222
    v_mfma_f32_16x16x32_bf16 v[140:143], v[88:91], a[20:23], v[140:143]
    v_mul_f32 v223, v63, v223
    v_cvt_pk_bf16_f32 v208, v208, v209
    v_cvt_pk_bf16_f32 v209, v210, v211
    v_cvt_pk_bf16_f32 v210, v212, v213
    v_mfma_f32_16x16x32_bf16 v[148:151], v[88:91], a[24:27], v[148:151]
    v_cvt_pk_bf16_f32 v211, v214, v215
    s_and_b32 s82, s2, 7
    s_lshr_b32 s83, s2, 6
    s_lshl2_add_u32 s82, s82, s83
    v_mfma_f32_16x16x32_bf16 v[156:159], v[88:91], a[28:31], v[156:159]
    buffer_store_dwordx4 v[208:211], v11, s[28:31], s70 offen offset:1024 sc1
    v_cvt_pk_bf16_f32 v216, v216, v217
    v_cvt_pk_bf16_f32 v217, v218, v219
    v_cvt_pk_bf16_f32 v218, v220, v221
    s_waitcnt lgkmcnt(2)
    v_mfma_f32_16x16x32_bf16 v[96:99], v[72:75], a[32:35], v[96:99]
    ds_read_b64_tr_b16 v[84:85], v27 offset:16384
    v_cvt_pk_bf16_f32 v219, v222, v223
    s_bfe_u32 s83, s2, 0x30003
    v_cmp_eq_u32 s[46:47], 0, v0
    v_mfma_f32_16x16x32_bf16 v[104:107], v[72:75], a[36:39], v[104:107]
    ds_read_b64_tr_b16 v[86:87], v27 offset:16896
    buffer_store_dwordx4 v[216:219], v11, s[28:31], s71 offen offset:1024 sc1
    v_mul_f32 v224, v58, v224
    v_mul_f32 v225, v58, v225
    v_mfma_f32_16x16x32_bf16 v[112:115], v[72:75], a[40:43], v[112:115]
    ds_read_b64_tr_b16 v[88:89], v27 offset:24576
    v_mul_f32 v226, v58, v226
    v_mul_f32 v227, v58, v227
    v_mul_f32 v228, v58, v228
    v_mfma_f32_16x16x32_bf16 v[120:123], v[72:75], a[44:47], v[120:123]
    ds_read_b64_tr_b16 v[90:91], v27 offset:25088
    v_mul_f32 v229, v58, v229
    v_mul_f32 v230, v58, v230
    v_mul_f32 v231, v58, v231
    v_mfma_f32_16x16x32_bf16 v[44:47], v[72:75], v[36:39], v[44:47]
    v_mul_f32 v232, v59, v232
    v_mul_f32 v233, v59, v233
    v_mul_f32 v234, v59, v234
    v_mul_f32 v235, v59, v235
    s_waitcnt lgkmcnt(4)
    v_mfma_f32_16x16x32_bf16 v[128:131], v[76:79], a[32:35], v[128:131]
    v_mul_f32 v236, v59, v236
    v_mul_f32 v237, v59, v237
    v_mul_f32 v238, v59, v238
    v_mul_f32 v239, v59, v239
    v_mfma_f32_16x16x32_bf16 v[136:139], v[76:79], a[36:39], v[136:139]
    v_cvt_pk_bf16_f32 v224, v224, v225
    v_cvt_pk_bf16_f32 v225, v226, v227
    v_cvt_pk_bf16_f32 v226, v228, v229
    v_cvt_pk_bf16_f32 v227, v230, v231
    v_mfma_f32_16x16x32_bf16 v[144:147], v[76:79], a[40:43], v[144:147]
    buffer_store_dwordx4 v[224:227], v12, s[28:31], s72 offen offset:0 sc1
    v_cvt_pk_bf16_f32 v232, v232, v233
    v_cvt_pk_bf16_f32 v233, v234, v235
    v_cvt_pk_bf16_f32 v234, v236, v237
    v_mfma_f32_16x16x32_bf16 v[152:155], v[76:79], a[44:47], v[152:155]
    v_cvt_pk_bf16_f32 v235, v238, v239
    v_mov_b32 v17, 0x40000000
    s_lshl2_add_u32 s44, s2, s48
    s_lshl_b32 s44, s44, 7
    v_mfma_f32_16x16x32_bf16 v[48:51], v[76:79], v[36:39], v[48:51]
    buffer_store_dwordx4 v[232:235], v12, s[28:31], s73 offen offset:0 sc1
    v_mul_f32 v240, v62, v240
    v_mul_f32 v241, v62, v241
    v_mul_f32 v242, v62, v242
    s_waitcnt lgkmcnt(2)
    v_mfma_f32_16x16x32_bf16 v[100:103], v[84:87], a[32:35], v[100:103]
    ds_read_b64_tr_b16 v[72:73], v28 offset:16384
    v_mul_f32 v243, v62, v243
    v_mul_f32 v244, v62, v244
    v_mul_f32 v245, v62, v245
    v_mfma_f32_16x16x32_bf16 v[108:111], v[84:87], a[36:39], v[108:111]
    ds_read_b64_tr_b16 v[74:75], v28 offset:16896
    v_mul_f32 v246, v62, v246
    v_mul_f32 v247, v62, v247
    v_mul_f32 v248, v63, v248
    v_mfma_f32_16x16x32_bf16 v[116:119], v[84:87], a[40:43], v[116:119]
    ds_read_b64_tr_b16 v[76:77], v28 offset:24576
    v_mul_f32 v249, v63, v249
    v_mul_f32 v250, v63, v250
    v_mul_f32 v251, v63, v251
    v_mfma_f32_16x16x32_bf16 v[124:127], v[84:87], a[44:47], v[124:127]
    ds_read_b64_tr_b16 v[78:79], v28 offset:25088
    v_mul_f32 v252, v63, v252
    v_mul_f32 v253, v63, v253
    v_mul_f32 v254, v63, v254
    v_mfma_f32_16x16x32_bf16 v[44:47], v[84:87], v[40:43], v[44:47]
    v_mul_f32 v255, v63, v255
    v_cvt_pk_bf16_f32 v240, v240, v241
    v_cvt_pk_bf16_f32 v241, v242, v243
    v_cvt_pk_bf16_f32 v242, v244, v245
    s_waitcnt lgkmcnt(4)
    v_mfma_f32_16x16x32_bf16 v[132:135], v[88:91], a[32:35], v[132:135]
    v_cvt_pk_bf16_f32 v243, v246, v247
    v_cndmask_b32 v17, v17, 0, s[46:47]
    s_lshr_b32 s84, s82, 2
    s_mul_i32 s85, s84, 43
    v_mfma_f32_16x16x32_bf16 v[140:143], v[88:91], a[36:39], v[140:143]
    buffer_store_dwordx4 v[240:243], v12, s[28:31], s72 offen offset:1024 sc1
    v_cvt_pk_bf16_f32 v248, v248, v249
    v_cvt_pk_bf16_f32 v249, v250, v251
    v_cvt_pk_bf16_f32 v250, v252, v253
    v_mfma_f32_16x16x32_bf16 v[148:151], v[88:91], a[40:43], v[148:151]
    v_cvt_pk_bf16_f32 v251, v254, v255
    s_lshr_b32 s85, s85, 7
    s_mul_i32 s86, s85, 190
    s_lshl_b32 s87, s84, 6
    v_mfma_f32_16x16x32_bf16 v[156:159], v[88:91], a[44:47], v[156:159]
    buffer_store_dwordx4 v[248:251], v12, s[28:31], s73 offen offset:1024 sc1
    s_sub_u32 s86, s87, s86
    v_mov_b32 v22, s86
    s_add_u32 s85, s84, 8
    v_mfma_f32_16x16x32_bf16 v[48:51], v[88:91], v[40:43], v[48:51]
    s_mul_i32 s85, s85, 43
    s_lshr_b32 s85, s85, 7
    s_mul_i32 s86, s85, 190
    s_add_u32 s87, s87, 512
    s_waitcnt lgkmcnt(2)
    v_mfma_f32_16x16x32_bf16 v[96:99], v[72:75], a[48:51], v[96:99]
    ds_read_b64_tr_b16 v[84:85], v29 offset:16384
    s_sub_u32 s86, s87, s86
    v_mfma_f32_16x16x32_bf16 v[104:107], v[72:75], a[52:55], v[104:107]
    ds_read_b64_tr_b16 v[86:87], v29 offset:16896
    s_lshl1_add_u32 s85, s85, 184
    v_mfma_f32_16x16x32_bf16 v[112:115], v[72:75], a[56:59], v[112:115]
    ds_read_b64_tr_b16 v[88:89], v29 offset:24576
    s_cmp_lt_u32 s84, 4
    s_cselect_b32 s86, s86, s85
    v_mfma_f32_16x16x32_bf16 v[120:123], v[72:75], a[60:63], v[120:123]
    ds_read_b64_tr_b16 v[90:91], v29 offset:25088
    v_mov_b32 v190, s86
    s_waitcnt lgkmcnt(4)
    v_mfma_f32_16x16x32_bf16 v[128:131], v[76:79], a[48:51], v[128:131]
    s_add_u32 s85, s84, 16
    s_mul_i32 s85, s85, 43
    v_mfma_f32_16x16x32_bf16 v[136:139], v[76:79], a[52:55], v[136:139]
    s_lshr_b32 s85, s85, 7
    s_lshl1_add_u32 s85, s85, 184
    v_mfma_f32_16x16x32_bf16 v[144:147], v[76:79], a[56:59], v[144:147]
    v_mov_b32 v191, s85
    v_bfe_u32 v24, v0, 3, 2
    v_mfma_f32_16x16x32_bf16 v[152:155], v[76:79], a[60:63], v[152:155]
    v_cmp_eq_u32 s[46:47], 1, v24
    s_lshl_b32 s84, s83, 1
    s_waitcnt lgkmcnt(2)
    v_mfma_f32_16x16x32_bf16 v[100:103], v[84:87], a[48:51], v[100:103]
    ds_read_b64_tr_b16 v[72:73], v26 offset:49152
    s_add_u32 s55, s55, 1
    v_mfma_f32_16x16x32_bf16 v[108:111], v[84:87], a[52:55], v[108:111]
    ds_read_b64_tr_b16 v[74:75], v26 offset:49664
    s_and_b32 s55, s55, 7
    v_mfma_f32_16x16x32_bf16 v[116:119], v[84:87], a[56:59], v[116:119]
    ds_read_b64_tr_b16 v[76:77], v26 offset:57344
    s_mul_i32 s59, s55, 229376
    v_mfma_f32_16x16x32_bf16 v[124:127], v[84:87], a[60:63], v[124:127]
    ds_read_b64_tr_b16 v[78:79], v26 offset:57856
    s_add_u32 m0, s80, 131072
    s_waitcnt lgkmcnt(4)
    v_mfma_f32_16x16x32_bf16 v[132:135], v[88:91], a[48:51], v[132:135]
    buffer_load_dwordx4 v20, s[20:23], s59 offen offset:0 lds
    s_sub_u32 s84, s84, 2
    v_mfma_f32_16x16x32_bf16 v[140:143], v[88:91], a[52:55], v[140:143]
    buffer_load_dwordx4 v21, s[20:23], s59 offen offset:1024 lds
    s_add_u32 m0, s80, 139264
    v_mfma_f32_16x16x32_bf16 v[148:151], v[88:91], a[56:59], v[148:151]
    v_add_u32 v26, 0x10000, v26
    v_cndmask_b32 v22, v22, v190, s[46:47]
    v_mfma_f32_16x16x32_bf16 v[156:159], v[88:91], a[60:63], v[156:159]
    v_cmp_eq_u32 s[46:47], 2, v24
    v_bfe_u32 v190, v0, 1, 2
    s_waitcnt lgkmcnt(2)
    v_mfma_f32_16x16x32_bf16 v[96:99], v[72:75], a[64:67], v[96:99]
    ds_read_b64_tr_b16 v[84:85], v27 offset:49152
    buffer_load_dwordx4 v20, s[24:27], s59 offen offset:0 lds
    v_mfma_f32_16x16x32_bf16 v[104:107], v[72:75], a[68:71], v[104:107]
    ds_read_b64_tr_b16 v[86:87], v27 offset:49664
    v_add_u32 v23, s84, v190
    v_mfma_f32_16x16x32_bf16 v[112:115], v[72:75], a[72:75], v[112:115]
    ds_read_b64_tr_b16 v[88:89], v27 offset:57344
    v_cndmask_b32 v22, v22, v191, s[46:47]
    v_mfma_f32_16x16x32_bf16 v[120:123], v[72:75], a[76:79], v[120:123]
    ds_read_b64_tr_b16 v[90:91], v27 offset:57856
    v_max_i32 v23, 0, v23
    v_mfma_f32_16x16x32_bf16 v[44:47], v[72:75], v[36:39], v[44:47]
    buffer_load_dwordx4 v21, s[24:27], s59 offen offset:1024 lds
    s_add_u32 s55, s55, 1
    s_waitcnt lgkmcnt(4)
    v_mfma_f32_16x16x32_bf16 v[128:131], v[76:79], a[64:67], v[128:131]
    s_and_b32 s55, s55, 7
    s_mul_i32 s59, s55, 229376
    v_mfma_f32_16x16x32_bf16 v[136:139], v[76:79], a[68:71], v[136:139]
    v_add_u32 v27, 0x10000, v27
    s_add_u32 m0, s80, 147456
    v_mfma_f32_16x16x32_bf16 v[144:147], v[76:79], a[72:75], v[144:147]
    v_lshrrev_b32 v191, 3, v23
    v_add_u32 v22, v22, v191
    v_mfma_f32_16x16x32_bf16 v[152:155], v[76:79], a[76:79], v[152:155]
    buffer_load_dwordx4 v20, s[20:23], s59 offen offset:0 lds
    v_and_b32 v23, 7, v23
    v_mfma_f32_16x16x32_bf16 v[48:51], v[76:79], v[36:39], v[48:51]
    v_lshl_add_u32 v22, v23, 3, v22
    v_and_b32 v191, 1, v0
    s_waitcnt lgkmcnt(2)
    v_mfma_f32_16x16x32_bf16 v[100:103], v[84:87], a[64:67], v[100:103]
    ds_read_b64_tr_b16 v[72:73], v28 offset:49152
    v_lshl_add_u32 v22, v22, 2, v191
    v_mfma_f32_16x16x32_bf16 v[108:111], v[84:87], a[68:71], v[108:111]
    ds_read_b64_tr_b16 v[74:75], v28 offset:49664
    s_and_b32 s84, s82, 2
    v_mfma_f32_16x16x32_bf16 v[116:119], v[84:87], a[72:75], v[116:119]
    ds_read_b64_tr_b16 v[76:77], v28 offset:57344
    buffer_load_dwordx4 v21, s[20:23], s59 offen offset:1024 lds
    v_mfma_f32_16x16x32_bf16 v[124:127], v[84:87], a[76:79], v[124:127]
    ds_read_b64_tr_b16 v[78:79], v28 offset:57856
    s_add_u32 m0, s80, 155648
    v_mfma_f32_16x16x32_bf16 v[44:47], v[84:87], v[40:43], v[44:47]
    v_add_u32 v22, s84, v22
    s_lshr_b32 s84, s82, 4
    s_waitcnt lgkmcnt(4)
    v_mfma_f32_16x16x32_bf16 v[132:135], v[88:91], a[64:67], v[132:135]
    s_bfe_u32 s85, s82, 0x30001
    s_lshl3_add_u32 s84, s85, s84
    v_mfma_f32_16x16x32_bf16 v[140:143], v[88:91], a[68:71], v[140:143]
    v_add_u32 v28, 0x10000, v28
    s_lshl1_add_u32 s84, s48, s84
    v_mfma_f32_16x16x32_bf16 v[148:151], v[88:91], a[72:75], v[148:151]
    buffer_load_dwordx4 v20, s[24:27], s59 offen offset:0 lds
    s_and_b32 s85, s82, 1
    v_mfma_f32_16x16x32_bf16 v[156:159], v[88:91], a[76:79], v[156:159]
    s_lshl2_add_u32 s84, s84, s85
    v_lshlrev_b32 v190, 8, v190
    v_mfma_f32_16x16x32_bf16 v[48:51], v[88:91], v[40:43], v[48:51]
    v_lshl_add_u32 v190, v191, 1, v190
    v_add_u32 v23, s84, v190
    s_waitcnt lgkmcnt(2)
    v_mfma_f32_16x16x32_bf16 v[96:99], v[72:75], a[80:83], v[96:99]
    ds_read_b64_tr_b16 v[84:85], v29 offset:49152
    buffer_load_dwordx4 v21, s[24:27], s59 offen offset:1024 lds
    v_mfma_f32_16x16x32_bf16 v[104:107], v[72:75], a[84:87], v[104:107]
    ds_read_b64_tr_b16 v[86:87], v29 offset:49664
    v_cmp_eq_u32 s[46:47], 3, v24
    v_mfma_f32_16x16x32_bf16 v[112:115], v[72:75], a[88:91], v[112:115]
    ds_read_b64_tr_b16 v[88:89], v29 offset:57344
    v_bfe_u32 v190, v0, 2, 2
    v_mfma_f32_16x16x32_bf16 v[120:123], v[72:75], a[92:95], v[120:123]
    ds_read_b64_tr_b16 v[90:91], v29 offset:57856
    v_and_b32 v191, 3, v0
    s_waitcnt lgkmcnt(4)
    v_mfma_f32_16x16x32_bf16 v[128:131], v[76:79], a[80:83], v[128:131]
    v_cndmask_b32 v22, v22, v23, s[46:47]
    s_mov_b32 s86, 131072
    v_mfma_f32_16x16x32_bf16 v[136:139], v[76:79], a[84:87], v[136:139]
    s_mov_b32 s87, 393216
    v_lshl_add_u32 v22, v22, 7, s86
    v_mfma_f32_16x16x32_bf16 v[144:147], v[76:79], a[88:91], v[144:147]
    v_add_u32 v29, 0x10000, v29
    v_lshl_add_u32 v23, v23, 7, s87
    v_mfma_f32_16x16x32_bf16 v[152:155], v[76:79], a[92:95], v[152:155]
    v_lshl_add_u32 v190, v191, 6, v190
    s_lshr_b32 s84, s82, 2
    s_waitcnt lgkmcnt(2)
    v_mfma_f32_16x16x32_bf16 v[100:103], v[84:87], a[80:83], v[100:103]
    ds_read_b64_tr_b16 v[72:73], v26 offset:0
    v_mov_b32 v188, s60
    v_mfma_f32_16x16x32_bf16 v[108:111], v[84:87], a[84:87], v[108:111]
    ds_read_b64_tr_b16 v[74:75], v26 offset:512
    v_mov_b32 v189, s61
    v_mfma_f32_16x16x32_bf16 v[116:119], v[84:87], a[88:91], v[116:119]
    ds_read_b64_tr_b16 v[76:77], v26 offset:8192
    s_add_u32 s44, s44, 0x20000
    s_waitcnt vmcnt(8)
    v_mfma_f32_16x16x32_bf16 v[124:127], v[84:87], a[92:95], v[124:127]
    ds_read_b64_tr_b16 v[78:79], v26 offset:8704
    buffer_store_dwordx2 v[188:189], v17, s[28:31], s44 offen sc1
    s_waitcnt lgkmcnt(4)
    v_mfma_f32_16x16x32_bf16 v[132:135], v[88:91], a[80:83], v[132:135]
    s_lshl_b32 s84, s84, 1
    s_add_u32 s84, s84, s50
    v_mfma_f32_16x16x32_bf16 v[140:143], v[88:91], a[84:87], v[140:143]
    s_lshl_b32 s84, s84, 4
    s_and_b32 s85, s82, 3
    v_mfma_f32_16x16x32_bf16 v[148:151], v[88:91], a[88:91], v[148:151]
    s_add_u32 s84, s84, s85
    s_add_u32 s84, s84, 4096
    v_mfma_f32_16x16x32_bf16 v[156:159], v[88:91], a[92:95], v[156:159]
    v_lshl_add_u32 v190, v190, 2, s84
    v_lshlrev_b32 v24, 7, v190
    s_waitcnt lgkmcnt(2)
    v_mfma_f32_16x16x32_bf16 v[96:99], v[72:75], a[96:99], v[96:99]
    ds_read_b64_tr_b16 v[84:85], v27 offset:0
    s_lshr_b32 s62, s2, 3
    v_mfma_f32_16x16x32_bf16 v[104:107], v[72:75], a[100:103], v[104:107]
    ds_read_b64_tr_b16 v[86:87], v27 offset:512
    s_lshl2_add_u32 s62, s62, s48
    v_mfma_f32_16x16x32_bf16 v[112:115], v[72:75], a[104:107], v[112:115]
    ds_read_b64_tr_b16 v[88:89], v27 offset:8192
    v_mov_b32 v35, 0x40000000
    v_mfma_f32_16x16x32_bf16 v[120:123], v[72:75], a[108:111], v[120:123]
    ds_read_b64_tr_b16 v[90:91], v27 offset:8704
    v_mad_u32_u24 v2, s62, 14, v0
    v_mfma_f32_16x16x32_bf16 v[44:47], v[72:75], v[36:39], v[44:47]
    v_cmp_gt_u32 vcc, 14, v0
    v_lshlrev_b32 v2, 10, v2
    s_waitcnt lgkmcnt(4)
    v_mfma_f32_16x16x32_bf16 v[128:131], v[76:79], a[96:99], v[128:131]
    v_lshl_add_u32 v3, s62, 2, v0
    v_cndmask_b32 v2, v35, v2, vcc
    v_mfma_f32_16x16x32_bf16 v[136:139], v[76:79], a[100:103], v[136:139]
    v_cmp_gt_u32 vcc, 4, v0
    v_lshlrev_b32 v3, 10, v3
    v_mfma_f32_16x16x32_bf16 v[144:147], v[76:79], a[104:107], v[144:147]
    buffer_load_dword v2, v2, s[32:35], 0 offen offset:384
    v_cndmask_b32 v3, v35, v3, vcc
    v_mfma_f32_16x16x32_bf16 v[152:155], v[76:79], a[108:111], v[152:155]
    buffer_load_dword v3, v3, s[36:39], 0 offen offset:384
    v_mfma_f32_16x16x32_bf16 v[48:51], v[76:79], v[36:39], v[48:51]
    s_waitcnt lgkmcnt(2)
    v_mfma_f32_16x16x32_bf16 v[100:103], v[84:87], a[96:99], v[100:103]
    ds_read_b64_tr_b16 v[72:73], v28 offset:0
    s_cmp_eq_u32 s83, 0
    s_cselect_b32 s86, 0xff800000, 0
    v_mfma_f32_16x16x32_bf16 v[108:111], v[84:87], a[100:103], v[108:111]
    ds_read_b64_tr_b16 v[74:75], v28 offset:512
    s_mov_b32 s87, s86
    v_mfma_f32_16x16x32_bf16 v[116:119], v[84:87], a[104:107], v[116:119]
    ds_read_b64_tr_b16 v[76:77], v28 offset:8192
    v_mov_b64 v[240:241], s[86:87]
    v_mfma_f32_16x16x32_bf16 v[124:127], v[84:87], a[108:111], v[124:127]
    ds_read_b64_tr_b16 v[78:79], v28 offset:8704
    v_mov_b64 v[242:243], s[86:87]
    v_mfma_f32_16x16x32_bf16 v[44:47], v[84:87], v[40:43], v[44:47]
    v_mov_b64 v[244:245], s[86:87]
    v_mov_b64 v[246:247], s[86:87]
    s_waitcnt lgkmcnt(4)
    v_mfma_f32_16x16x32_bf16 v[132:135], v[88:91], a[96:99], v[132:135]
    v_mov_b64 v[248:249], s[86:87]
    v_mov_b64 v[250:251], s[86:87]
    v_mfma_f32_16x16x32_bf16 v[140:143], v[88:91], a[100:103], v[140:143]
    v_mov_b64 v[252:253], s[86:87]
    v_mov_b64 v[254:255], s[86:87]
    v_mfma_f32_16x16x32_bf16 v[148:151], v[88:91], a[104:107], v[148:151]
    v_mfma_f32_16x16x32_bf16 v[156:159], v[88:91], a[108:111], v[156:159]
    v_mfma_f32_16x16x32_bf16 v[48:51], v[88:91], v[40:43], v[48:51]
    s_waitcnt lgkmcnt(2)
    v_mfma_f32_16x16x32_bf16 v[96:99], v[72:75], a[112:115], v[96:99]
    ds_read_b64_tr_b16 v[84:85], v29 offset:0
    v_mfma_f32_16x16x32_bf16 v[104:107], v[72:75], a[116:119], v[104:107]
    ds_read_b64_tr_b16 v[86:87], v29 offset:512
    v_mfma_f32_16x16x32_bf16 v[112:115], v[72:75], a[120:123], v[112:115]
    ds_read_b64_tr_b16 v[88:89], v29 offset:8192
    v_mfma_f32_16x16x32_bf16 v[120:123], v[72:75], a[124:127], v[120:123]
    ds_read_b64_tr_b16 v[90:91], v29 offset:8704
    s_waitcnt lgkmcnt(4)
    v_mfma_f32_16x16x32_bf16 v[128:131], v[76:79], a[112:115], v[128:131]
    v_mfma_f32_16x16x32_bf16 v[136:139], v[76:79], a[116:119], v[136:139]
    v_mfma_f32_16x16x32_bf16 v[144:147], v[76:79], a[120:123], v[144:147]
    v_mfma_f32_16x16x32_bf16 v[152:155], v[76:79], a[124:127], v[152:155]
    s_waitcnt lgkmcnt(0)
    s_barrier
    v_mfma_f32_16x16x32_bf16 v[100:103], v[84:87], a[112:115], v[100:103]
    ds_read_b64_tr_b16 v[72:73], v26 offset:16384
    s_add_u32 m0, s79, 32768
    v_mfma_f32_16x16x32_bf16 v[108:111], v[84:87], a[116:119], v[108:111]
    ds_read_b64_tr_b16 v[74:75], v26 offset:16896
    buffer_load_dwordx4 v13, s[32:35], s45 offen offset:0 lds
    v_mfma_f32_16x16x32_bf16 v[116:119], v[84:87], a[120:123], v[116:119]
    ds_read_b64_tr_b16 v[76:77], v26 offset:24576
    buffer_load_dwordx4 v14, s[32:35], s45 offen offset:1024 lds
    v_mfma_f32_16x16x32_bf16 v[124:127], v[84:87], a[124:127], v[124:127]
    ds_read_b64_tr_b16 v[78:79], v26 offset:25088
    v_add_u32 v20, 98304, v18
    v_mfma_f32_16x16x32_bf16 v[132:135], v[88:91], a[112:115], v[132:135]
    v_add_u32 v21, 98304, v19
    s_lshl_b32 s84, s48, 1
    v_mfma_f32_16x16x32_bf16 v[140:143], v[88:91], a[116:119], v[140:143]
    s_sub_u32 s57, 8, s84
    s_lshl3_add_u32 s84, s83, s84
    v_mfma_f32_16x16x32_bf16 v[148:151], v[88:91], a[120:123], v[148:151]
    buffer_load_dwordx4 v15, s[32:35], s45 offen offset:2048 lds
    s_lshl_b32 s56, s84, 5
    v_mfma_f32_16x16x32_bf16 v[156:159], v[88:91], a[124:127], v[156:159]
    s_add_u32 s56, s56, s82
    s_lshl_b32 s56, s56, 10
    s_waitcnt lgkmcnt(2)
    v_mfma_f32_16x16x32_bf16 v[96:99], v[72:75], a[128:131], v[96:99]
    ds_read_b64_tr_b16 v[84:85], v27 offset:16384
    s_add_u32 s56, s56, 7340032
    v_mfma_f32_16x16x32_bf16 v[104:107], v[72:75], a[132:135], v[104:107]
    ds_read_b64_tr_b16 v[86:87], v27 offset:16896
    buffer_load_dwordx4 v16, s[32:35], s45 offen offset:3072 lds
    v_mfma_f32_16x16x32_bf16 v[112:115], v[72:75], a[136:139], v[112:115]
    ds_read_b64_tr_b16 v[88:89], v27 offset:24576
    s_add_u32 s45, s45, 32768
    v_mfma_f32_16x16x32_bf16 v[120:123], v[72:75], a[140:143], v[120:123]
    ds_read_b64_tr_b16 v[90:91], v27 offset:25088
    s_add_u32 m0, s79, 0
    v_mfma_f32_16x16x32_bf16 v[44:47], v[72:75], v[36:39], v[44:47]
    s_lshl_b32 s53, s82, 6
    s_add_u32 s51, s53, s84
    s_waitcnt lgkmcnt(4)
    v_mfma_f32_16x16x32_bf16 v[128:131], v[76:79], a[128:131], v[128:131]
    s_lshl_b32 s51, s51, 10
    s_add_u32 s51, s51, 1048576
    v_mfma_f32_16x16x32_bf16 v[136:139], v[76:79], a[132:135], v[136:139]
    buffer_load_dwordx4 v13, s[32:35], s45 offen offset:0 lds
    s_lshl1_add_u32 s84, s83, s48
    v_mfma_f32_16x16x32_bf16 v[144:147], v[76:79], a[136:139], v[144:147]
    s_sub_u32 s84, s84, 2
    s_max_i32 s84, s84, 0
    v_mfma_f32_16x16x32_bf16 v[152:155], v[76:79], a[140:143], v[152:155]
    s_lshl2_add_u32 s53, s84, s53
    s_lshl_b32 s53, s53, 10
    v_mfma_f32_16x16x32_bf16 v[48:51], v[76:79], v[36:39], v[48:51]
    s_add_u32 s52, s53, 3145728
    s_add_u32 s53, s53, 5242880
    s_waitcnt lgkmcnt(2)
    v_mfma_f32_16x16x32_bf16 v[100:103], v[84:87], a[128:131], v[100:103]
    ds_read_b64_tr_b16 v[72:73], v28 offset:16384
    buffer_load_dwordx4 v14, s[32:35], s45 offen offset:1024 lds
    v_mfma_f32_16x16x32_bf16 v[108:111], v[84:87], a[132:135], v[108:111]
    ds_read_b64_tr_b16 v[74:75], v28 offset:16896
    s_lshl1_add_u32 s84, s82, s49
    v_mfma_f32_16x16x32_bf16 v[116:119], v[84:87], a[136:139], v[116:119]
    ds_read_b64_tr_b16 v[76:77], v28 offset:24576
    s_xor_b32 s85, s84, 1
    v_mfma_f32_16x16x32_bf16 v[124:127], v[84:87], a[140:143], v[124:127]
    ds_read_b64_tr_b16 v[78:79], v28 offset:25088
    buffer_load_dwordx4 v15, s[32:35], s45 offen offset:2048 lds
    v_mfma_f32_16x16x32_bf16 v[44:47], v[84:87], v[40:43], v[44:47]
    s_mul_i32 s58, s84, 114688
    s_mul_i32 s54, s85, 114688
    s_waitcnt lgkmcnt(4)
    v_mfma_f32_16x16x32_bf16 v[132:135], v[88:91], a[128:131], v[132:135]
    s_mul_i32 s85, s48, 12288
    s_add_u32 s85, s85, 9437184
    v_mfma_f32_16x16x32_bf16 v[140:143], v[88:91], a[132:135], v[140:143]
    s_add_u32 s58, s58, s85
    s_add_u32 s54, s54, s85
    v_mfma_f32_16x16x32_bf16 v[148:151], v[88:91], a[136:139], v[148:151]
    s_lshl_b32 s85, s48, 12
    s_add_u32 s85, s85, 49152
    v_mfma_f32_16x16x32_bf16 v[156:159], v[88:91], a[140:143], v[156:159]
    buffer_load_dwordx4 v16, s[32:35], s45 offen offset:3072 lds
    s_add_u32 s45, s45, 32768
    v_mfma_f32_16x16x32_bf16 v[48:51], v[88:91], v[40:43], v[48:51]
    s_add_u32 m0, s79, 16384
    s_add_u32 s65, s58, s85
    s_waitcnt lgkmcnt(2)
    v_mfma_f32_16x16x32_bf16 v[96:99], v[72:75], a[144:147], v[96:99]
    ds_read_b64_tr_b16 v[84:85], v29 offset:16384
    s_add_u32 s66, s54, s85
    v_mfma_f32_16x16x32_bf16 v[104:107], v[72:75], a[148:151], v[104:107]
    ds_read_b64_tr_b16 v[86:87], v29 offset:16896
    buffer_load_dwordx4 v13, s[32:35], s45 offen offset:0 lds
    v_mfma_f32_16x16x32_bf16 v[112:115], v[72:75], a[152:155], v[112:115]
    ds_read_b64_tr_b16 v[88:89], v29 offset:24576
    s_lshl1_add_u32 s78, s84, s50
    v_mfma_f32_16x16x32_bf16 v[120:123], v[72:75], a[156:159], v[120:123]
    ds_read_b64_tr_b16 v[90:91], v29 offset:25088
    s_lshl_b32 s78, s78, 14
    s_waitcnt lgkmcnt(4)
    v_mfma_f32_16x16x32_bf16 v[128:131], v[76:79], a[144:147], v[128:131]
    s_add_u32 s78, s78, 7340032
    s_lshl_b32 s64, s84, 9
    v_mfma_f32_16x16x32_bf16 v[136:139], v[76:79], a[148:151], v[136:139]
    s_add_u32 s64, s64, 65536
    s_lshl_b32 s63, s84, 15
    v_mfma_f32_16x16x32_bf16 v[144:147], v[76:79], a[152:155], v[144:147]
    buffer_load_dwordx4 v14, s[32:35], s45 offen offset:1024 lds
    s_xor_b32 s84, s83, 0
    v_mfma_f32_16x16x32_bf16 v[152:155], v[76:79], a[156:159], v[152:155]
    s_lshl1_add_u32 s84, s84, s50
    s_lshl_b32 s84, s84, 6
    s_waitcnt lgkmcnt(2)
    v_mfma_f32_16x16x32_bf16 v[100:103], v[84:87], a[144:147], v[100:103]
    ds_read_b64_tr_b16 v[72:73], v26 offset:32768
    s_add_u32 s63, s63, s84
    v_mfma_f32_16x16x32_bf16 v[108:111], v[84:87], a[148:151], v[108:111]
    ds_read_b64_tr_b16 v[74:75], v26 offset:33280
    buffer_load_dwordx4 v15, s[32:35], s45 offen offset:2048 lds
    v_mfma_f32_16x16x32_bf16 v[116:119], v[84:87], a[152:155], v[116:119]
    ds_read_b64_tr_b16 v[76:77], v26 offset:40960
    v_and_b32 v12, 15, v0
    v_mfma_f32_16x16x32_bf16 v[124:127], v[84:87], a[156:159], v[124:127]
    ds_read_b64_tr_b16 v[78:79], v26 offset:41472
    v_lshrrev_b32 v11, 5, v0
    s_waitcnt lgkmcnt(4)
    v_mfma_f32_16x16x32_bf16 v[132:135], v[88:91], a[144:147], v[132:135]
    v_lshlrev_b32 v12, 10, v12
    v_lshl_add_u32 v12, v11, 4, v12
    v_mfma_f32_16x16x32_bf16 v[140:143], v[88:91], a[148:151], v[140:143]
    v_and_b32 v11, 16, v0
    v_lshl_add_u32 v12, v11, 1, v12
    v_mfma_f32_16x16x32_bf16 v[148:151], v[88:91], a[152:155], v[148:151]
    v_add_u32 v26, 0x10000, v26
    v_mfma_f32_16x16x32_bf16 v[156:159], v[88:91], a[156:159], v[156:159]
    buffer_load_dwordx4 v16, s[32:35], s45 offen offset:3072 lds
    s_add_u32 s45, s45, 32768
    s_waitcnt lgkmcnt(2)
    v_mfma_f32_16x16x32_bf16 v[96:99], v[72:75], a[160:163], v[96:99]
    ds_read_b64_tr_b16 v[84:85], v27 offset:32768
    s_add_u32 m0, s79, 49152
    v_mfma_f32_16x16x32_bf16 v[104:107], v[72:75], a[164:167], v[104:107]
    ds_read_b64_tr_b16 v[86:87], v27 offset:33280
    buffer_load_dwordx4 v13, s[32:35], s45 offen offset:0 lds
    v_mfma_f32_16x16x32_bf16 v[112:115], v[72:75], a[168:171], v[112:115]
    ds_read_b64_tr_b16 v[88:89], v27 offset:40960
    v_lshrrev_b32 v208, 5, v0
    v_mfma_f32_16x16x32_bf16 v[120:123], v[72:75], a[172:175], v[120:123]
    ds_read_b64_tr_b16 v[90:91], v27 offset:41472
    v_and_b32 v209, 15, v0
    v_mfma_f32_16x16x32_bf16 v[44:47], v[72:75], v[36:39], v[44:47]
    v_lshlrev_b32 v209, 3, v209
    v_lshl_add_u32 v209, v208, 7, v209
    s_waitcnt lgkmcnt(4)
    v_mfma_f32_16x16x32_bf16 v[128:131], v[76:79], a[160:163], v[128:131]
    s_lshl_b32 s84, s48, 11
    s_add_u32 s84, s84, 65536
    v_mfma_f32_16x16x32_bf16 v[136:139], v[76:79], a[164:167], v[136:139]
    v_add_u32 v27, 0x10000, v27
    v_add_u32 v210, s84, v209
    v_mfma_f32_16x16x32_bf16 v[144:147], v[76:79], a[168:171], v[144:147]
    buffer_load_dwordx4 v14, s[32:35], s45 offen offset:1024 lds
    v_add_u32 v170, s84, v1
    v_mfma_f32_16x16x32_bf16 v[152:155], v[76:79], a[172:175], v[152:155]
    v_add_u32 v170, 16384, v170
    s_add_u32 s84, s79, 114688
    v_mfma_f32_16x16x32_bf16 v[48:51], v[76:79], v[36:39], v[48:51]
    v_xor_b32 v209, 128, v209
    v_add_u32 v209, s84, v209
    s_waitcnt lgkmcnt(2)
    v_mfma_f32_16x16x32_bf16 v[100:103], v[84:87], a[160:163], v[100:103]
    ds_read_b64_tr_b16 v[72:73], v28 offset:32768
    buffer_load_dwordx2 v[190:191], v22, s[28:31], 0 offen sc1
    v_mfma_f32_16x16x32_bf16 v[108:111], v[84:87], a[164:167], v[108:111]
    ds_read_b64_tr_b16 v[74:75], v28 offset:33280
    buffer_load_dwordx4 v15, s[32:35], s45 offen offset:2048 lds
    v_mfma_f32_16x16x32_bf16 v[116:119], v[84:87], a[168:171], v[116:119]
    ds_read_b64_tr_b16 v[76:77], v28 offset:40960
    v_add_u32 v211, s84, v1
    v_mfma_f32_16x16x32_bf16 v[124:127], v[84:87], a[172:175], v[124:127]
    ds_read_b64_tr_b16 v[78:79], v28 offset:41472
    buffer_load_dwordx4 v16, s[32:35], s45 offen offset:3072 lds
    s_waitcnt vmcnt(13)
    v_mfma_f32_16x16x32_bf16 v[44:47], v[84:87], v[40:43], v[44:47]
    ds_read_b64_tr_b16 a[0:1], v18 offset:32768
    ds_read_b64_tr_b16 a[2:3], v18 offset:33792
    s_waitcnt lgkmcnt(6)
    v_mfma_f32_16x16x32_bf16 v[132:135], v[88:91], a[160:163], v[132:135]
    ds_read_b64_tr_b16 a[4:5], v19 offset:32768
    ds_read_b64_tr_b16 a[6:7], v19 offset:33792
    v_mfma_f32_16x16x32_bf16 v[140:143], v[88:91], a[164:167], v[140:143]
    v_add_u32 v28, 0x10000, v28
    v_and_b32 v176, 16, v0
    v_mfma_f32_16x16x32_bf16 v[148:151], v[88:91], a[168:171], v[148:151]
    ds_read_b64_tr_b16 a[8:9], v18 offset:34816
    ds_read_b64_tr_b16 a[10:11], v18 offset:35840
    v_mfma_f32_16x16x32_bf16 v[156:159], v[88:91], a[172:175], v[156:159]
    ds_read_b64_tr_b16 a[12:13], v19 offset:34816
    ds_read_b64_tr_b16 a[14:15], v19 offset:35840
    s_waitcnt vmcnt(9)
    v_mfma_f32_16x16x32_bf16 v[48:51], v[88:91], v[40:43], v[48:51]
    ds_read_b64_tr_b16 a[16:17], v18 offset:0
    ds_read_b64_tr_b16 a[18:19], v18 offset:1024
    s_waitcnt lgkmcnt(12)
    v_mfma_f32_16x16x32_bf16 v[96:99], v[72:75], a[176:179], v[96:99]
    ds_read_b64_tr_b16 v[84:85], v29 offset:32768
    ds_read_b64_tr_b16 a[20:21], v19 offset:0
    v_mfma_f32_16x16x32_bf16 v[104:107], v[72:75], a[180:183], v[104:107]
    ds_read_b64_tr_b16 v[86:87], v29 offset:33280
    s_waitcnt lgkmcnt(8)
    ds_read_b64_tr_b16 a[22:23], v19 offset:1024
    v_mfma_f32_16x16x32_bf16 v[112:115], v[72:75], a[184:187], v[112:115]
    ds_read_b64_tr_b16 v[88:89], v29 offset:40960
    ds_read_b64_tr_b16 a[24:25], v18 offset:2048
    v_mfma_f32_16x16x32_bf16 v[120:123], v[72:75], a[188:191], v[120:123]
    ds_read_b64_tr_b16 v[90:91], v29 offset:41472
    ds_read_b64_tr_b16 a[26:27], v18 offset:3072
    v_mfma_f32_16x16x32_bf16 v[128:131], v[76:79], a[176:179], v[128:131]
    ds_read_b64_tr_b16 a[28:29], v19 offset:2048
    ds_read_b64_tr_b16 a[30:31], v19 offset:3072
    v_mfma_f32_16x16x32_bf16 v[136:139], v[76:79], a[180:183], v[136:139]
    v_cmp_eq_u32 s[86:87], 0, v176
    v_mov_b32 v177, 1024
    v_mfma_f32_16x16x32_bf16 v[144:147], v[76:79], a[184:187], v[144:147]
    v_add_u32 v29, 0x10000, v29
    v_and_b32 v176, 31, v0
    v_mfma_f32_16x16x32_bf16 v[152:155], v[76:79], a[188:191], v[152:155]
    v_cndmask_b32 v160, v209, v210, s[86:87]
    v_cndmask_b32 v210, 0, v177, s[86:87]
    s_waitcnt lgkmcnt(0)
    s_barrier
    v_mfma_f32_16x16x32_bf16 v[100:103], v[84:87], a[176:179], v[100:103]
    ds_read_b64_tr_b16 v[72:73], v26 offset:0
    v_lshlrev_b32 v208, 2, v208
    v_mfma_f32_16x16x32_bf16 v[108:111], v[84:87], a[180:183], v[108:111]
    ds_read_b64_tr_b16 v[74:75], v26 offset:512
    v_sub_u32 v176, v176, v208
    v_mfma_f32_16x16x32_bf16 v[116:119], v[84:87], a[184:187], v[116:119]
    ds_read_b64_tr_b16 v[76:77], v26 offset:8192
    s_add_u32 s45, s45, 32768
    v_mfma_f32_16x16x32_bf16 v[124:127], v[84:87], a[188:191], v[124:127]
    ds_read_b64_tr_b16 v[78:79], v26 offset:8704
    s_add_u32 m0, s79, 32768
    v_mfma_f32_16x16x32_bf16 v[132:135], v[88:91], a[176:179], v[132:135]
    buffer_load_dwordx4 v13, s[32:35], s45 offen offset:0 lds
    v_mov_b32 v177, 0xffff
    v_mfma_f32_16x16x32_bf16 v[140:143], v[88:91], a[180:183], v[140:143]
    buffer_load_dwordx4 v14, s[32:35], s45 offen offset:1024 lds
    v_mov_b32 v178, 0xff800000
    v_mfma_f32_16x16x32_bf16 v[148:151], v[88:91], a[184:187], v[148:151]
    v_mov_b32 v179, 0xff800000
    v_add_u32 v161, v160, v210
    v_mfma_f32_16x16x32_bf16 v[156:159], v[88:91], a[188:191], v[156:159]
    v_add_u32 v162, v161, v210
    v_add_u32 v163, v162, v210
    s_waitcnt lgkmcnt(2)
    v_mfma_f32_16x16x32_bf16 v[96:99], v[72:75], a[192:195], v[96:99]
    ds_read_b64_tr_b16 v[84:85], v27 offset:0
    buffer_load_dwordx4 v15, s[32:35], s45 offen offset:2048 lds
    v_mfma_f32_16x16x32_bf16 v[104:107], v[72:75], a[196:199], v[104:107]
    ds_read_b64_tr_b16 v[86:87], v27 offset:512
    v_add_u32 v164, v163, v210
    v_mfma_f32_16x16x32_bf16 v[112:115], v[72:75], a[200:203], v[112:115]
    ds_read_b64_tr_b16 v[88:89], v27 offset:8192
    v_add_u32 v165, v164, v210
    v_mfma_f32_16x16x32_bf16 v[120:123], v[72:75], a[204:207], v[120:123]
    ds_read_b64_tr_b16 v[90:91], v27 offset:8704
    v_add_u32 v166, v165, v210
    v_mfma_f32_16x16x32_bf16 v[44:47], v[72:75], v[36:39], v[44:47]
    buffer_load_dwordx4 v16, s[32:35], s45 offen offset:3072 lds
    s_add_u32 s45, s45, 32768
    s_waitcnt lgkmcnt(4)
    v_mfma_f32_16x16x32_bf16 v[128:131], v[76:79], a[192:195], v[128:131]
    s_add_u32 m0, s79, 0
    v_add_u32 v167, v166, v210
    v_mfma_f32_16x16x32_bf16 v[136:139], v[76:79], a[196:199], v[136:139]
    v_add_u32 v168, v167, v210
    v_add_u32 v169, v168, v210
    v_mfma_f32_16x16x32_bf16 v[144:147], v[76:79], a[200:203], v[144:147]
    v_mov_b32 v212, 0x3f803f80
    v_mov_b32 v213, 0x3f803f80
    v_mfma_f32_16x16x32_bf16 v[152:155], v[76:79], a[204:207], v[152:155]
    buffer_load_dwordx4 v13, s[32:35], s45 offen offset:0 lds
    v_mov_b32 v214, 0x3f803f80
    v_mfma_f32_16x16x32_bf16 v[48:51], v[76:79], v[36:39], v[48:51]
    v_mov_b32 v215, 0x3f803f80
    v_lshlrev_b32 v208, v176, 2
    s_waitcnt lgkmcnt(2)
    v_mfma_f32_16x16x32_bf16 v[100:103], v[84:87], a[192:195], v[100:103]
    ds_read_b64_tr_b16 v[72:73], v28 offset:0
    buffer_load_dwordx4 v14, s[32:35], s45 offen offset:1024 lds
    v_mfma_f32_16x16x32_bf16 v[108:111], v[84:87], a[196:199], v[108:111]
    ds_read_b64_tr_b16 v[74:75], v28 offset:512
    buffer_load_dwordx4 v15, s[32:35], s45 offen offset:2048 lds
    v_mfma_f32_16x16x32_bf16 v[116:119], v[84:87], a[200:203], v[116:119]
    ds_read_b64_tr_b16 v[76:77], v28 offset:8192
    buffer_load_dwordx4 v16, s[32:35], s45 offen offset:3072 lds
    s_waitcnt vmcnt(13)
    v_mfma_f32_16x16x32_bf16 v[124:127], v[84:87], a[204:207], v[124:127]
    ds_read_b64_tr_b16 v[78:79], v28 offset:8704
    ds_read_b64_tr_b16 a[32:33], v18 offset:16384
    v_mfma_f32_16x16x32_bf16 v[44:47], v[84:87], v[40:43], v[44:47]
    ds_read_b64_tr_b16 a[34:35], v18 offset:17408
    ds_read_b64_tr_b16 a[36:37], v19 offset:16384
    s_waitcnt lgkmcnt(7)
    v_mfma_f32_16x16x32_bf16 v[132:135], v[88:91], a[192:195], v[132:135]
    ds_read_b64_tr_b16 a[38:39], v19 offset:17408
    ds_read_b64_tr_b16 a[40:41], v18 offset:18432
    v_mfma_f32_16x16x32_bf16 v[140:143], v[88:91], a[196:199], v[140:143]
    ds_read_b64_tr_b16 a[42:43], v18 offset:19456
    ds_read_b64_tr_b16 a[44:45], v19 offset:18432
    v_mfma_f32_16x16x32_bf16 v[148:151], v[88:91], a[200:203], v[148:151]
    ds_read_b64_tr_b16 a[46:47], v19 offset:19456
    s_waitcnt vmcnt(8)
    ds_read_b64_tr_b16 a[48:49], v18 offset:49152
    v_mfma_f32_16x16x32_bf16 v[156:159], v[88:91], a[204:207], v[156:159]
    ds_read_b64_tr_b16 a[50:51], v18 offset:50176
    ds_read_b64_tr_b16 a[52:53], v19 offset:49152
    v_mfma_f32_16x16x32_bf16 v[48:51], v[88:91], v[40:43], v[48:51]
    s_waitcnt lgkmcnt(8)
    ds_read_b64_tr_b16 a[54:55], v19 offset:50176
    ds_read_b64_tr_b16 a[56:57], v18 offset:51200
    v_mfma_f32_16x16x32_bf16 v[96:99], v[72:75], a[208:211], v[96:99]
    ds_read_b64_tr_b16 v[84:85], v29 offset:0
    ds_read_b64_tr_b16 a[58:59], v18 offset:52224
    v_mfma_f32_16x16x32_bf16 v[104:107], v[72:75], a[212:215], v[104:107]
    ds_read_b64_tr_b16 v[86:87], v29 offset:512
    ds_read_b64_tr_b16 a[60:61], v19 offset:51200
    v_mfma_f32_16x16x32_bf16 v[112:115], v[72:75], a[216:219], v[112:115]
    ds_read_b64_tr_b16 v[88:89], v29 offset:8192
    s_waitcnt lgkmcnt(8)
    ds_read_b64_tr_b16 a[62:63], v19 offset:52224
L_qb_chk:
    v_cmp_ne_u64 s[46:47], s[60:61], v[190:191]
    s_cmp_lg_u64 s[46:47], 0
    s_cbranch_scc1 L_qb_retry
L_qb_ok:
    v_mfma_f32_16x16x32_bf16 v[120:123], v[72:75], a[220:223], v[120:123]
    ds_read_b64_tr_b16 v[90:91], v29 offset:8704
    buffer_load_dwordx4 a[128:131], v1, s[28:31], s51 offen offset:0 sc1
    v_mfma_f32_16x16x32_bf16 v[128:131], v[76:79], a[208:211], v[128:131]
    buffer_load_dwordx4 a[132:135], v1, s[28:31], s51 offen offset:1024 sc1
    s_add_u32 m0, s79, 81920
    v_mfma_f32_16x16x32_bf16 v[136:139], v[76:79], a[212:215], v[136:139]
    buffer_load_dwordx4 v1, s[28:31], s52 offen offset:0 sc1 lds
    v_ashrrev_i32 v209, 31, v176
    v_mfma_f32_16x16x32_bf16 v[144:147], v[76:79], a[216:219], v[144:147]
    buffer_load_dwordx4 v1, s[28:31], s52 offen offset:1024 sc1 lds
    v_add_u32 v208, -1, v208
    v_mfma_f32_16x16x32_bf16 v[152:155], v[76:79], a[220:223], v[152:155]
    buffer_load_dwordx4 v1, s[28:31], s52 offen offset:2048 sc1 lds
    v_bfi_b32 v208, v209, 0, v208
    s_waitcnt lgkmcnt(4)
    v_mfma_f32_16x16x32_bf16 v[100:103], v[84:87], a[208:211], v[100:103]
    ds_read_b64_tr_b16 v[72:73], v26 offset:16384
    buffer_load_dwordx4 v1, s[28:31], s52 offen offset:3072 sc1 lds
    v_mfma_f32_16x16x32_bf16 v[108:111], v[84:87], a[212:215], v[108:111]
    ds_read_b64_tr_b16 v[74:75], v26 offset:16896
    s_add_u32 m0, s79, 65536
    v_mfma_f32_16x16x32_bf16 v[116:119], v[84:87], a[216:219], v[116:119]
    ds_read_b64_tr_b16 v[76:77], v26 offset:24576
    v_bfe_i32 v192, v208, 0, 1
    v_mfma_f32_16x16x32_bf16 v[124:127], v[84:87], a[220:223], v[124:127]
    ds_read_b64_tr_b16 v[78:79], v26 offset:25088
    buffer_load_dwordx4 v1, s[28:31], s53 offen offset:0 sc1 lds
    s_waitcnt lgkmcnt(4)
    v_mfma_f32_16x16x32_bf16 v[132:135], v[88:91], a[208:211], v[132:135]
    v_bfe_i32 v193, v208, 1, 1
    v_bfe_i32 v194, v208, 2, 1
    v_mfma_f32_16x16x32_bf16 v[140:143], v[88:91], a[212:215], v[140:143]
    v_bfe_i32 v195, v208, 3, 1
    v_bfe_i32 v196, v208, 8, 1
    v_mfma_f32_16x16x32_bf16 v[148:151], v[88:91], a[216:219], v[148:151]
    v_bfe_i32 v197, v208, 9, 1
    v_bfe_i32 v198, v208, 10, 1
    v_mfma_f32_16x16x32_bf16 v[156:159], v[88:91], a[220:223], v[156:159]
    v_bfe_i32 v199, v208, 11, 1
    v_bfe_i32 v200, v208, 16, 1
    s_waitcnt lgkmcnt(2)
    v_mfma_f32_16x16x32_bf16 v[96:99], v[72:75], a[224:227], v[96:99]
    ds_read_b64_tr_b16 v[84:85], v27 offset:16384
    buffer_load_dwordx4 v1, s[28:31], s53 offen offset:1024 sc1 lds
    v_mfma_f32_16x16x32_bf16 v[104:107], v[72:75], a[228:231], v[104:107]
    ds_read_b64_tr_b16 v[86:87], v27 offset:16896
    v_bfe_i32 v201, v208, 17, 1
    v_mfma_f32_16x16x32_bf16 v[112:115], v[72:75], a[232:235], v[112:115]
    ds_read_b64_tr_b16 v[88:89], v27 offset:24576
    v_bfe_i32 v202, v208, 18, 1
    v_mfma_f32_16x16x32_bf16 v[120:123], v[72:75], a[236:239], v[120:123]
    ds_read_b64_tr_b16 v[90:91], v27 offset:25088
    buffer_load_dwordx4 v1, s[28:31], s53 offen offset:2048 sc1 lds
    v_mfma_f32_16x16x32_bf16 v[44:47], v[72:75], v[36:39], v[44:47]
    v_bfe_i32 v203, v208, 19, 1
    v_bfe_i32 v204, v208, 24, 1
    s_waitcnt lgkmcnt(4)
    v_mfma_f32_16x16x32_bf16 v[128:131], v[76:79], a[224:227], v[128:131]
    v_bfe_i32 v205, v208, 25, 1
    v_bfe_i32 v206, v208, 26, 1
    v_mfma_f32_16x16x32_bf16 v[136:139], v[76:79], a[228:231], v[136:139]
    v_bfe_i32 v207, v208, 27, 1
    v_bfi_b32 v180, v177, v192, v193
    v_mfma_f32_16x16x32_bf16 v[144:147], v[76:79], a[232:235], v[144:147]
    v_bfi_b32 v181, v177, v194, v195
    v_bfi_b32 v182, v177, v196, v197
    v_mfma_f32_16x16x32_bf16 v[152:155], v[76:79], a[236:239], v[152:155]
    buffer_load_dwordx4 v1, s[28:31], s53 offen offset:3072 sc1 lds
    s_lshl_b32 s62, s48, 16
    s_add_u32 s45, s45, s62
    v_mfma_f32_16x16x32_bf16 v[48:51], v[76:79], v[36:39], v[48:51]
    s_add_u32 s45, s45, 622592
    s_add_u32 m0, s79, 16384
    s_waitcnt lgkmcnt(2)
    v_mfma_f32_16x16x32_bf16 v[100:103], v[84:87], a[224:227], v[100:103]
    ds_read_b64_tr_b16 v[72:73], v28 offset:16384
    v_bfi_b32 v183, v177, v198, v199
    v_mfma_f32_16x16x32_bf16 v[108:111], v[84:87], a[228:231], v[108:111]
    ds_read_b64_tr_b16 v[74:75], v28 offset:16896
    buffer_load_dwordx4 v13, s[32:35], s45 offen offset:0 lds
    v_mfma_f32_16x16x32_bf16 v[116:119], v[84:87], a[232:235], v[116:119]
    ds_read_b64_tr_b16 v[76:77], v28 offset:24576
    v_bfi_b32 v184, v177, v200, v201
    v_mfma_f32_16x16x32_bf16 v[124:127], v[84:87], a[236:239], v[124:127]
    ds_read_b64_tr_b16 v[78:79], v28 offset:25088
    v_bfi_b32 v185, v177, v202, v203
    v_mfma_f32_16x16x32_bf16 v[44:47], v[84:87], v[40:43], v[44:47]
    v_bfi_b32 v186, v177, v204, v205
    v_bfi_b32 v187, v177, v206, v207
    s_waitcnt lgkmcnt(4)
    v_mfma_f32_16x16x32_bf16 v[132:135], v[88:91], a[224:227], v[132:135]
    buffer_load_dwordx4 v14, s[32:35], s45 offen offset:1024 lds
    v_and_b32 v10, 31, v0
    v_mfma_f32_16x16x32_bf16 v[140:143], v[88:91], a[228:231], v[140:143]
    v_lshlrev_b32 v10, 4, v10
    s_add_u32 s44, s44, 0x20000
    v_mfma_f32_16x16x32_bf16 v[148:151], v[88:91], a[232:235], v[148:151]
    v_cvt_pk_bf16_f32 v216, v44, v45
    v_cvt_pk_bf16_f32 v217, v46, v47
    v_mfma_f32_16x16x32_bf16 v[156:159], v[88:91], a[236:239], v[156:159]
    v_lshlrev_b32 v218, 16, v216
    v_and_b32 v219, 0xffff0000, v216
    v_mfma_f32_16x16x32_bf16 v[48:51], v[88:91], v[40:43], v[48:51]
    v_lshlrev_b32 v220, 16, v217
    v_and_b32 v221, 0xffff0000, v217
    s_waitcnt lgkmcnt(2)
    v_mfma_f32_16x16x32_bf16 v[96:99], v[72:75], a[240:243], v[96:99]
    ds_read_b64_tr_b16 v[84:85], v29 offset:16384
    v_sub_f32 v218, v44, v218
    v_mfma_f32_16x16x32_bf16 v[104:107], v[72:75], a[244:247], v[104:107]
    ds_read_b64_tr_b16 v[86:87], v29 offset:16896
    v_sub_f32 v219, v45, v219
    v_mfma_f32_16x16x32_bf16 v[112:115], v[72:75], a[248:251], v[112:115]
    ds_read_b64_tr_b16 v[88:89], v29 offset:24576
    v_sub_f32 v220, v46, v220
    v_mfma_f32_16x16x32_bf16 v[120:123], v[72:75], a[252:255], v[120:123]
    ds_read_b64_tr_b16 v[90:91], v29 offset:25088
    v_sub_f32 v221, v47, v221
    s_waitcnt lgkmcnt(4)
    v_mfma_f32_16x16x32_bf16 v[128:131], v[76:79], a[240:243], v[128:131]
    v_cvt_pk_bf16_f32 v222, v218, v219
    v_cvt_pk_bf16_f32 v223, v220, v221
    v_mfma_f32_16x16x32_bf16 v[136:139], v[76:79], a[244:247], v[136:139]
    ds_write_b64 v32, v[216:217] offset:2048
    ds_write_b64 v32, v[222:223] offset:2112
    v_mfma_f32_16x16x32_bf16 v[144:147], v[76:79], a[248:251], v[144:147]
    v_cvt_pk_bf16_f32 v216, v48, v49
    v_cvt_pk_bf16_f32 v217, v50, v51
    v_mfma_f32_16x16x32_bf16 v[152:155], v[76:79], a[252:255], v[152:155]
    v_lshlrev_b32 v218, 16, v216
    v_and_b32 v219, 0xffff0000, v216
    v_lshlrev_b32 v220, 16, v217
    v_and_b32 v221, 0xffff0000, v217
    v_sub_f32 v218, v48, v218
    v_sub_f32 v219, v49, v219
    v_sub_f32 v220, v50, v220
    v_sub_f32 v221, v51, v221
    v_cvt_pk_bf16_f32 v222, v218, v219
    v_cvt_pk_bf16_f32 v223, v220, v221
    ds_write_b64 v32, v[216:217] offset:2560
    ds_write_b64 v32, v[222:223] offset:2624
    s_waitcnt lgkmcnt(0)
    s_barrier
    s_bfe_u32 s84, s2, 0x30003
    s_cmp_eq_u32 s84, 0
    s_cselect_b32 s57, s57, 0
    v_mfma_f32_16x16x32_bf16 v[100:103], v[84:87], a[240:243], v[100:103]
    ds_read_b64_tr_b16 v[64:65], v33 offset:2048
    buffer_load_dwordx4 v15, s[32:35], s45 offen offset:2048 lds
    v_mfma_f32_16x16x32_bf16 v[108:111], v[84:87], a[244:247], v[108:111]
    ds_read_b64_tr_b16 v[66:67], v33 offset:2560
    buffer_load_dwordx4 v16, s[32:35], s45 offen offset:3072 lds
    v_mfma_f32_16x16x32_bf16 v[116:119], v[84:87], a[248:251], v[116:119]
    s_add_u32 s45, s45, 32768
    s_add_u32 m0, s79, 49152
    v_mfma_f32_16x16x32_bf16 v[124:127], v[84:87], a[252:255], v[124:127]
    buffer_load_dwordx4 v13, s[32:35], s45 offen offset:0 lds
    v_mfma_f32_16x16x32_bf16 v[132:135], v[88:91], a[240:243], v[132:135]
    buffer_load_dwordx4 v14, s[32:35], s45 offen offset:1024 lds
    v_mfma_f32_16x16x32_bf16 v[140:143], v[88:91], a[244:247], v[140:143]
    buffer_load_dwordx4 v15, s[32:35], s45 offen offset:2048 lds
    v_mfma_f32_16x16x32_bf16 v[148:151], v[88:91], a[248:251], v[148:151]
    v_mfma_f32_16x16x32_bf16 v[156:159], v[88:91], a[252:255], v[156:159]
    buffer_load_dwordx4 v16, s[32:35], s45 offen offset:3072 lds
    s_waitcnt lgkmcnt(1)
    v_mfma_f32_16x16x4_4b_bf16 v[96:111], v[64:65], v[56:57], v[96:111]
    s_waitcnt lgkmcnt(0)
    v_mfma_f32_16x16x4_4b_bf16 v[128:143], v[66:67], v[56:57], v[128:143]
    v_mfma_f32_16x16x4_4b_bf16 v[112:127], v[64:65], v[60:61], v[112:127]
    buffer_load_dwordx4 v[2:5], v12, s[4:7], s63 offen
    s_add_u32 s62, s63, 16384
    buffer_load_dwordx4 v[6:9], v12, s[4:7], s62 offen
    v_mfma_f32_16x16x4_4b_bf16 v[144:159], v[66:67], v[60:61], v[144:159]
L_p2done:
    s_nop 6
    v_pk_mul_f32 v[96:97], v[96:97], v[128:129]
    v_pk_mul_f32 v[98:99], v[98:99], v[130:131]
    v_pk_mul_f32 v[100:101], v[100:101], v[132:133]
    v_pk_mul_f32 v[102:103], v[102:103], v[134:135]
    v_pk_mul_f32 v[104:105], v[104:105], v[136:137]
    v_pk_mul_f32 v[106:107], v[106:107], v[138:139]
    v_pk_mul_f32 v[108:109], v[108:109], v[140:141]
    v_pk_mul_f32 v[110:111], v[110:111], v[142:143]
    v_cvt_pk_bf16_f32 v96, v96, v97
    v_cvt_pk_bf16_f32 v97, v98, v99
    v_cvt_pk_bf16_f32 v98, v100, v101
    v_cvt_pk_bf16_f32 v99, v102, v103
    buffer_store_dwordx4 v[96:99], v31, s[28:31], s76 offen offset:0 sc1
    v_cvt_pk_bf16_f32 v104, v104, v105
    v_cvt_pk_bf16_f32 v105, v106, v107
    v_cvt_pk_bf16_f32 v106, v108, v109
    v_cvt_pk_bf16_f32 v107, v110, v111
    buffer_store_dwordx4 v[104:107], v31, s[28:31], s76 offen offset:256 sc1
    v_pk_mul_f32 v[112:113], v[112:113], v[144:145]
    v_pk_mul_f32 v[114:115], v[114:115], v[146:147]
    v_pk_mul_f32 v[116:117], v[116:117], v[148:149]
    v_pk_mul_f32 v[118:119], v[118:119], v[150:151]
    v_pk_mul_f32 v[120:121], v[120:121], v[152:153]
    v_pk_mul_f32 v[122:123], v[122:123], v[154:155]
    v_pk_mul_f32 v[124:125], v[124:125], v[156:157]
    v_pk_mul_f32 v[126:127], v[126:127], v[158:159]
    v_cvt_pk_bf16_f32 v112, v112, v113
    v_cvt_pk_bf16_f32 v113, v114, v115
    v_cvt_pk_bf16_f32 v114, v116, v117
    v_cvt_pk_bf16_f32 v115, v118, v119
    buffer_store_dwordx4 v[112:115], v31, s[28:31], s77 offen offset:0 sc1
    v_cvt_pk_bf16_f32 v120, v120, v121
    v_cvt_pk_bf16_f32 v121, v122, v123
    v_cvt_pk_bf16_f32 v122, v124, v125
    v_cvt_pk_bf16_f32 v123, v126, v127
    buffer_store_dwordx4 v[120:123], v31, s[28:31], s77 offen offset:256 sc1
    s_waitcnt vmcnt(14)
    s_barrier
    ds_read_b128 a[164:167], v170 offset:8192
    ds_read_b128 a[232:235], v170 offset:0
    ds_read_b128 a[236:239], v170 offset:9216
    ds_read_b128 a[136:139], v170 offset:1024
    ds_write_b128 v211, v[212:215]
    ds_read_b128 a[140:143], v170 offset:2048
    buffer_load_dwordx4 a[96:99], v1, s[28:31], s58 offen offset:0 sc1
    buffer_load_dwordx4 a[100:103], v1, s[28:31], s54 offen offset:0 sc1
    s_waitcnt lgkmcnt(5)
    v_mfma_f32_32x32x16_bf16 v[32:47], a[164:167], a[128:131], 0
    s_waitcnt lgkmcnt(4)
    v_mfma_f32_32x32x16_bf16 v[64:79], a[232:235], a[128:131], v[240:255]
    s_waitcnt lgkmcnt(3)
    v_mfma_f32_32x32x16_bf16 v[48:63], a[236:239], a[132:135], 0
    ds_read_b128 a[144:147], v170 offset:3072
    ds_read_b128 a[148:151], v170 offset:4096
    ds_read_b128 a[152:155], v170 offset:5120
    ds_read_b128 a[156:159], v170 offset:6144
    ds_read_b128 a[160:163], v170 offset:7168
    buffer_load_dwordx4 a[104:107], v1, s[28:31], s58 offen offset:1024 sc1
    s_nop 3
    v_bfi_b32 v32, v192, v32, v64
    v_bfi_b32 v33, v193, v33, v65
    v_bfi_b32 v34, v194, v34, v66
    v_bfi_b32 v35, v195, v35, v67
    s_waitcnt lgkmcnt(7)
    v_mfma_f32_32x32x16_bf16 v[80:95], a[136:139], a[132:135], v[240:255]
    v_bfi_b32 v36, v196, v36, v68
    v_bfi_b32 v37, v197, v37, v69
    v_bfi_b32 v38, v198, v38, v70
    v_bfi_b32 v39, v199, v39, v71
    v_bfi_b32 v40, v200, v40, v72
    v_bfi_b32 v41, v201, v41, v73
    v_bfi_b32 v42, v202, v42, v74
    v_bfi_b32 v43, v203, v43, v75
    v_mfma_f32_32x32x16_bf16 v[96:111], a[136:139], a[128:131], 0
    buffer_load_dwordx4 a[108:111], v1, s[28:31], s54 offen offset:1024 sc1
    v_bfi_b32 v44, v204, v44, v76
    v_bfi_b32 v45, v205, v45, v77
    v_bfi_b32 v46, v206, v46, v78
    v_bfi_b32 v47, v207, v47, v79
    v_max3_f32 v238, v178, v32, v33
    v_max3_f32 v238, v238, v34, v35
    v_max3_f32 v238, v238, v36, v37
    v_max3_f32 v238, v238, v38, v39
    s_waitcnt lgkmcnt(5)
    v_mfma_f32_32x32x16_bf16 v[112:127], a[140:143], a[128:131], 0
    v_max3_f32 v238, v238, v40, v41
    v_max3_f32 v238, v238, v42, v43
    v_max3_f32 v238, v238, v44, v45
    v_max3_f32 v238, v238, v46, v47
    v_bfi_b32 v48, v192, v48, v80
    v_bfi_b32 v49, v193, v49, v81
    v_bfi_b32 v50, v194, v50, v82
    v_bfi_b32 v51, v195, v51, v83
    v_bfi_b32 v52, v196, v52, v84
    v_bfi_b32 v53, v197, v53, v85
    v_bfi_b32 v54, v198, v54, v86
    v_bfi_b32 v55, v199, v55, v87
    v_bfi_b32 v56, v200, v56, v88
    v_bfi_b32 v57, v201, v57, v89
    v_bfi_b32 v58, v202, v58, v90
    v_bfi_b32 v59, v203, v59, v91
    v_bfi_b32 v60, v204, v60, v92
    v_bfi_b32 v61, v205, v61, v93
    v_bfi_b32 v62, v206, v62, v94
    v_bfi_b32 v63, v207, v63, v95
    buffer_load_dwordx4 a[112:115], v1, s[28:31], s58 offen offset:2048 sc1
    v_mfma_f32_32x32x16_bf16 v[128:143], a[140:143], a[132:135], 0
    ds_read_b64_tr_b16 a[168:169], v161 offset:0
    ds_read_b64_tr_b16 a[170:171], v161 offset:256
    ds_read_b64_tr_b16 a[172:173], v161 offset:512
    buffer_load_dwordx4 a[116:119], v1, s[28:31], s54 offen offset:2048 sc1
    v_max3_f32 v239, v179, v48, v49
    v_max3_f32 v239, v239, v50, v51
    v_max3_f32 v239, v239, v52, v53
    v_max3_f32 v239, v239, v54, v55
    v_max3_f32 v239, v239, v56, v57
    v_max3_f32 v239, v239, v58, v59
    v_max3_f32 v239, v239, v60, v61
    v_max3_f32 v239, v239, v62, v63
    v_max3_f32 v178, v238, v96, v97
    v_max3_f32 v178, v178, v98, v99
    v_max3_f32 v178, v178, v100, v101
    v_max3_f32 v178, v178, v102, v103
    v_max3_f32 v178, v178, v104, v105
    v_max3_f32 v178, v178, v106, v107
    v_max3_f32 v178, v178, v108, v109
    v_max3_f32 v178, v178, v110, v111
    s_waitcnt lgkmcnt(7)
    v_mfma_f32_32x32x16_bf16 v[96:111], a[144:147], a[128:131], 0
    ds_read_b64_tr_b16 a[174:175], v161 offset:768
    ds_read_b64_tr_b16 a[176:177], v162 offset:0
    ds_read_b64_tr_b16 a[178:179], v162 offset:256
    buffer_load_dwordx4 a[120:123], v1, s[28:31], s58 offen offset:3072 sc1
    s_cmp_eq_u32 s57, 2
    s_cbranch_scc1 L_at_m
L_at_m2_back:
    v_max3_f32 v178, v178, v112, v113
    v_max3_f32 v178, v178, v114, v115
    v_max3_f32 v178, v178, v116, v117
    v_max3_f32 v178, v178, v118, v119
    v_max3_f32 v178, v178, v120, v121
    v_max3_f32 v178, v178, v122, v123
    v_max3_f32 v178, v178, v124, v125
    v_max3_f32 v178, v178, v126, v127
    v_mfma_f32_32x32x16_bf16 v[112:127], a[144:147], a[132:135], 0
    ds_read_b64_tr_b16 a[180:181], v162 offset:512
    ds_read_b64_tr_b16 a[182:183], v162 offset:768
    ds_read_b64_tr_b16 a[184:185], v163 offset:0
    buffer_load_dwordx4 a[124:127], v1, s[28:31], s54 offen offset:3072 sc1
    s_add_u32 s58, s58, 4096
    s_add_u32 s54, s54, 4096
    s_add_u32 s45, s45, 32768
    s_add_u32 m0, s79, 98304
    v_max3_f32 v179, v239, v128, v129
    v_max3_f32 v179, v179, v130, v131
    v_max3_f32 v179, v179, v132, v133
    v_max3_f32 v179, v179, v134, v135
    v_max3_f32 v179, v179, v136, v137
    v_max3_f32 v179, v179, v138, v139
    v_max3_f32 v179, v179, v140, v141
    v_max3_f32 v179, v179, v142, v143
    s_waitcnt lgkmcnt(12)
    v_mfma_f32_32x32x16_bf16 v[128:143], a[148:151], a[128:131], 0
    ds_read_b64_tr_b16 a[186:187], v163 offset:256
    ds_read_b64_tr_b16 a[188:189], v163 offset:512
    ds_read_b64_tr_b16 a[190:191], v163 offset:768
    buffer_load_dwordx4 v13, s[32:35], s45 offen offset:0 lds
    s_waitcnt lgkmcnt(8)
    ds_read_b64_tr_b16 a[64:65], v18 offset:32768
    ds_read_b64_tr_b16 a[66:67], v18 offset:33792
    v_max3_f32 v178, v178, v96, v97
    v_max3_f32 v178, v178, v98, v99
    v_max3_f32 v178, v178, v100, v101
    v_max3_f32 v178, v178, v102, v103
    v_max3_f32 v178, v178, v104, v105
    v_max3_f32 v178, v178, v106, v107
    v_max3_f32 v178, v178, v108, v109
    v_max3_f32 v178, v178, v110, v111
    v_mfma_f32_32x32x16_bf16 v[96:111], a[148:151], a[132:135], 0
    ds_read_b64_tr_b16 a[192:193], v164 offset:0
    ds_read_b64_tr_b16 a[194:195], v164 offset:256
    ds_read_b64_tr_b16 a[196:197], v164 offset:512
    buffer_load_dwordx4 v14, s[32:35], s45 offen offset:1024 lds
    ds_read_b64_tr_b16 a[68:69], v19 offset:32768
    ds_read_b64_tr_b16 a[70:71], v19 offset:33792
    v_max3_f32 v179, v179, v112, v113
    v_max3_f32 v179, v179, v114, v115
    v_max3_f32 v179, v179, v116, v117
    v_max3_f32 v179, v179, v118, v119
    v_max3_f32 v179, v179, v120, v121
    v_max3_f32 v179, v179, v122, v123
    v_max3_f32 v179, v179, v124, v125
    v_max3_f32 v179, v179, v126, v127
    v_mfma_f32_32x32x16_bf16 v[112:127], a[152:155], a[128:131], 0
    s_waitcnt lgkmcnt(8)
    ds_read_b64_tr_b16 a[198:199], v164 offset:768
    ds_read_b64_tr_b16 a[200:201], v165 offset:0
    ds_read_b64_tr_b16 a[202:203], v165 offset:256
    buffer_load_dwordx4 v15, s[32:35], s45 offen offset:2048 lds
    ds_read_b64_tr_b16 a[72:73], v18 offset:34816
    ds_read_b64_tr_b16 a[74:75], v18 offset:35840
    s_cmp_eq_u32 s57, 4
    s_cbranch_scc1 L_at_m
L_at_m4_back:
    v_max3_f32 v178, v178, v128, v129
    v_max3_f32 v178, v178, v130, v131
    v_max3_f32 v178, v178, v132, v133
    v_max3_f32 v178, v178, v134, v135
    v_max3_f32 v178, v178, v136, v137
    v_max3_f32 v178, v178, v138, v139
    v_max3_f32 v178, v178, v140, v141
    v_max3_f32 v178, v178, v142, v143
    v_mfma_f32_32x32x16_bf16 v[128:143], a[152:155], a[132:135], 0
    ds_read_b64_tr_b16 a[204:205], v165 offset:512
    ds_read_b64_tr_b16 a[206:207], v165 offset:768
    s_waitcnt lgkmcnt(8)
    ds_read_b64_tr_b16 a[208:209], v166 offset:0
    buffer_load_dwordx4 v16, s[32:35], s45 offen offset:3072 lds
    ds_read_b64_tr_b16 a[76:77], v19 offset:34816
    ds_read_b64_tr_b16 a[78:79], v19 offset:35840
    s_add_u32 s45, s45, 32768
    s_add_u32 m0, s79, 131072
    v_max3_f32 v179, v179, v96, v97
    v_max3_f32 v179, v179, v98, v99
    v_max3_f32 v179, v179, v100, v101
    v_max3_f32 v179, v179, v102, v103
    v_max3_f32 v179, v179, v104, v105
    v_max3_f32 v179, v179, v106, v107
    v_max3_f32 v179, v179, v108, v109
    v_max3_f32 v179, v179, v110, v111
    v_mfma_f32_32x32x16_bf16 v[96:111], a[156:159], a[128:131], 0
    ds_read_b64_tr_b16 a[210:211], v166 offset:256
    ds_read_b64_tr_b16 a[212:213], v166 offset:512
    ds_read_b64_tr_b16 a[214:215], v166 offset:768
    buffer_load_dwordx4 v13, s[32:35], s45 offen offset:0 lds
    ds_read_b64_tr_b16 a[80:81], v18 offset:0
    s_waitcnt lgkmcnt(8)
    ds_read_b64_tr_b16 a[82:83], v18 offset:1024
    v_max3_f32 v178, v178, v112, v113
    v_max3_f32 v178, v178, v114, v115
    v_max3_f32 v178, v178, v116, v117
    v_max3_f32 v178, v178, v118, v119
    v_max3_f32 v178, v178, v120, v121
    v_max3_f32 v178, v178, v122, v123
    v_max3_f32 v178, v178, v124, v125
    v_max3_f32 v178, v178, v126, v127
    v_mfma_f32_32x32x16_bf16 v[112:127], a[156:159], a[132:135], 0
    ds_read_b64_tr_b16 a[216:217], v167 offset:0
    ds_read_b64_tr_b16 a[218:219], v167 offset:256
    ds_read_b64_tr_b16 a[220:221], v167 offset:512
    buffer_load_dwordx4 v14, s[32:35], s45 offen offset:1024 lds
    ds_read_b64_tr_b16 a[84:85], v19 offset:0
    ds_read_b64_tr_b16 a[86:87], v19 offset:1024
    v_max3_f32 v179, v179, v128, v129
    v_max3_f32 v179, v179, v130, v131
    v_max3_f32 v179, v179, v132, v133
    v_max3_f32 v179, v179, v134, v135
    v_max3_f32 v179, v179, v136, v137
    v_max3_f32 v179, v179, v138, v139
    v_max3_f32 v179, v179, v140, v141
    v_max3_f32 v179, v179, v142, v143
    v_mfma_f32_32x32x16_bf16 v[128:143], a[160:163], a[128:131], 0
    ds_read_b64_tr_b16 a[222:223], v167 offset:768
    s_waitcnt lgkmcnt(8)
    ds_read_b64_tr_b16 a[224:225], v168 offset:0
    ds_read_b64_tr_b16 a[226:227], v168 offset:256
    buffer_load_dwordx4 v15, s[32:35], s45 offen offset:2048 lds
    ds_read_b64_tr_b16 a[88:89], v18 offset:2048
    ds_read_b64_tr_b16 a[90:91], v18 offset:3072
    s_cmp_eq_u32 s57, 6
    s_cbranch_scc1 L_at_m
L_at_m6_back:
    v_max3_f32 v178, v178, v96, v97
    v_max3_f32 v178, v178, v98, v99
    v_max3_f32 v178, v178, v100, v101
    v_max3_f32 v178, v178, v102, v103
    v_max3_f32 v178, v178, v104, v105
    v_max3_f32 v178, v178, v106, v107
    v_max3_f32 v178, v178, v108, v109
    v_max3_f32 v178, v178, v110, v111
    v_mfma_f32_32x32x16_bf16 v[96:111], a[160:163], a[132:135], 0
    ds_read_b64_tr_b16 a[228:229], v168 offset:512
    ds_read_b64_tr_b16 a[230:231], v168 offset:768
    ds_read_b64_tr_b16 a[240:241], v160 offset:0
    buffer_load_dwordx4 v16, s[32:35], s45 offen offset:3072 lds
    s_waitcnt lgkmcnt(8)
    ds_read_b64_tr_b16 a[92:93], v19 offset:2048
    ds_read_b64_tr_b16 a[94:95], v19 offset:3072
    v_max3_f32 v179, v179, v112, v113
    v_max3_f32 v179, v179, v114, v115
    v_max3_f32 v179, v179, v116, v117
    v_max3_f32 v179, v179, v118, v119
    v_max3_f32 v179, v179, v120, v121
    v_max3_f32 v179, v179, v122, v123
    v_max3_f32 v179, v179, v124, v125
    v_max3_f32 v179, v179, v126, v127
    v_mfma_f32_32x32x16_bf16 v[112:127], a[164:167], a[132:135], 0
    ds_read_b64_tr_b16 a[242:243], v160 offset:256
    ds_read_b64_tr_b16 a[244:245], v160 offset:512
    ds_read_b64_tr_b16 a[246:247], v160 offset:768
    buffer_load_dwordx4 v[192:195], v1, s[28:31], s58 offen offset:0 sc1
    v_max3_f32 v178, v178, v128, v129
    v_max3_f32 v178, v178, v130, v131
    v_max3_f32 v178, v178, v132, v133
    v_max3_f32 v178, v178, v134, v135
    v_max3_f32 v178, v178, v136, v137
    v_max3_f32 v178, v178, v138, v139
    v_max3_f32 v178, v178, v140, v141
    v_max3_f32 v178, v178, v142, v143
    ds_read_b64_tr_b16 a[248:249], v169 offset:0
    ds_read_b64_tr_b16 a[250:251], v169 offset:256
    s_add_u32 s44, s44, 0x20000
    s_waitcnt vmcnt(17)
    buffer_store_dwordx2 v[188:189], v17, s[28:31], s44 offen sc1
    v_max3_f32 v179, v179, v96, v97
    v_max3_f32 v179, v179, v98, v99
    v_max3_f32 v179, v179, v100, v101
    v_max3_f32 v179, v179, v102, v103
    v_max3_f32 v179, v179, v104, v105
    v_max3_f32 v179, v179, v106, v107
    v_max3_f32 v179, v179, v108, v109
    v_max3_f32 v179, v179, v110, v111
    s_waitcnt lgkmcnt(8)
    ds_read_b64_tr_b16 a[252:253], v169 offset:512
    ds_read_b64_tr_b16 a[254:255], v169 offset:768
    buffer_load_dwordx4 v[196:199], v1, s[28:31], s54 offen offset:0 sc1
    s_cmp_eq_u32 s57, 8
    s_cbranch_scc1 L_at_m
L_at_m8_back:
    v_max3_f32 v179, v179, v112, v113
    v_max3_f32 v179, v179, v114, v115
    v_max3_f32 v179, v179, v116, v117
    v_max3_f32 v179, v179, v118, v119
    v_max3_f32 v179, v179, v120, v121
    v_max3_f32 v179, v179, v122, v123
    v_max3_f32 v179, v179, v124, v125
    v_max3_f32 v179, v179, v126, v127
    buffer_load_dwordx4 v[200:203], v1, s[28:31], s58 offen offset:1024 sc1
    s_nop 0
    v_permlane32_swap_b32 v178, v179
    v_min_f32 v80, -v178, -v179
    v_min_f32 v64, -v178, -v179
    s_nop 1
    v_permlane32_swap_b32 v64, v80
    v_pk_add_f32 v[32:33], v[32:33], v[64:65] op_sel_hi:[1,0]
    v_pk_add_f32 v[34:35], v[34:35], v[64:65] op_sel_hi:[1,0]
    v_pk_add_f32 v[36:37], v[36:37], v[64:65] op_sel_hi:[1,0]
    v_pk_add_f32 v[38:39], v[38:39], v[64:65] op_sel_hi:[1,0]
    v_pk_add_f32 v[40:41], v[40:41], v[64:65] op_sel_hi:[1,0]
    v_pk_add_f32 v[42:43], v[42:43], v[64:65] op_sel_hi:[1,0]
    v_pk_add_f32 v[44:45], v[44:45], v[64:65] op_sel_hi:[1,0]
    v_pk_add_f32 v[46:47], v[46:47], v[64:65] op_sel_hi:[1,0]
    v_pk_add_f32 v[48:49], v[48:49], v[80:81] op_sel_hi:[1,0]
    v_pk_add_f32 v[50:51], v[50:51], v[80:81] op_sel_hi:[1,0]
    v_pk_add_f32 v[52:53], v[52:53], v[80:81] op_sel_hi:[1,0]
    v_pk_add_f32 v[54:55], v[54:55], v[80:81] op_sel_hi:[1,0]
    v_pk_add_f32 v[56:57], v[56:57], v[80:81] op_sel_hi:[1,0]
    v_pk_add_f32 v[58:59], v[58:59], v[80:81] op_sel_hi:[1,0]
    v_pk_add_f32 v[60:61], v[60:61], v[80:81] op_sel_hi:[1,0]
    v_pk_add_f32 v[62:63], v[62:63], v[80:81] op_sel_hi:[1,0]
    buffer_load_dwordx4 v[204:207], v1, s[28:31], s54 offen offset:1024 sc1
    v_mov_b32 v81, v80
    v_mov_b64 v[82:83], v[80:81]
    v_mov_b64 v[84:85], v[80:81]
    v_mov_b64 v[86:87], v[80:81]
    v_mov_b64 v[88:89], v[80:81]
    v_mov_b64 v[90:91], v[80:81]
    v_mov_b64 v[92:93], v[80:81]
    v_mov_b64 v[94:95], v[80:81]
    buffer_load_dwordx4 v[208:211], v1, s[28:31], s58 offen offset:2048 sc1
    v_exp_f32 v32, v32
    v_exp_f32 v33, v33
    v_exp_f32 v34, v34
    v_exp_f32 v35, v35
    v_exp_f32 v36, v36
    v_exp_f32 v37, v37
    v_exp_f32 v38, v38
    v_exp_f32 v39, v39
    buffer_load_dwordx4 v[212:215], v1, s[28:31], s54 offen offset:2048 sc1
    v_cvt_pk_bf16_f32 v168, v32, v33
    v_cvt_pk_bf16_f32 v169, v34, v35
    v_cvt_pk_bf16_f32 v170, v36, v37
    v_cvt_pk_bf16_f32 v171, v38, v39
    v_and_b32 v160, v180, v168
    v_and_b32 v161, v181, v169
    v_and_b32 v162, v182, v170
    v_and_b32 v163, v183, v171
    v_xor_b32 v168, v160, v168
    v_xor_b32 v169, v161, v169
    v_xor_b32 v170, v162, v170
    v_xor_b32 v171, v163, v171
    v_exp_f32 v40, v40
    v_exp_f32 v41, v41
    v_mfma_f32_32x32x16_bf16 v[128:143], a[224:227], v[160:163], 0
    buffer_load_dwordx4 v[216:219], v1, s[28:31], s58 offen offset:3072 sc1
    v_exp_f32 v42, v42
    v_exp_f32 v43, v43
    v_exp_f32 v44, v44
    s_waitcnt lgkmcnt(6)
    v_mfma_f32_32x32x16_bf16 v[128:143], a[240:243], v[168:171], v[128:143]
    v_exp_f32 v45, v45
    v_exp_f32 v46, v46
    v_exp_f32 v47, v47
    v_cvt_pk_bf16_f32 v172, v40, v41
    v_cvt_pk_bf16_f32 v173, v42, v43
    v_cvt_pk_bf16_f32 v174, v44, v45
    v_cvt_pk_bf16_f32 v175, v46, v47
    v_and_b32 v164, v184, v172
    v_and_b32 v165, v185, v173
    v_and_b32 v166, v186, v174
    v_and_b32 v167, v187, v175
    v_xor_b32 v172, v164, v172
    v_xor_b32 v173, v165, v173
    v_xor_b32 v174, v166, v174
    v_xor_b32 v175, v167, v175
    v_mfma_f32_32x32x16_bf16 v[128:143], a[228:231], v[164:167], v[128:143]
    buffer_load_dwordx4 v[220:223], v1, s[28:31], s54 offen offset:3072 sc1
    s_add_u32 s58, s58, 4096
    s_add_u32 s54, s54, 4096
    s_add_u32 s45, s45, 32768
    s_add_u32 m0, s79, 147456
    v_mov_b32 v65, v64
    v_mov_b64 v[66:67], v[64:65]
    v_mov_b64 v[68:69], v[64:65]
    v_mov_b64 v[70:71], v[64:65]
    v_mov_b64 v[72:73], v[64:65]
    v_mov_b64 v[74:75], v[64:65]
    v_mov_b64 v[76:77], v[64:65]
    v_mov_b64 v[78:79], v[64:65]
    s_waitcnt lgkmcnt(4)
    v_mfma_f32_32x32x16_bf16 v[128:143], a[244:247], v[172:175], v[128:143]
    buffer_load_dwordx4 v13, s[32:35], s45 offen offset:0 lds
    v_exp_f32 v48, v48
    v_exp_f32 v49, v49
    v_exp_f32 v50, v50
    v_exp_f32 v51, v51
    v_mfma_f32_32x32x16_bf16 v[96:111], a[164:167], a[132:135], v[80:95]
    buffer_load_dwordx4 v14, s[32:35], s45 offen offset:1024 lds
    v_exp_f32 v52, v52
    v_exp_f32 v53, v53
    v_exp_f32 v54, v54
    v_exp_f32 v55, v55
    v_cvt_pk_bf16_f32 v168, v48, v49
    v_cvt_pk_bf16_f32 v169, v50, v51
    v_cvt_pk_bf16_f32 v170, v52, v53
    v_cvt_pk_bf16_f32 v171, v54, v55
    v_and_b32 v160, v180, v168
    v_and_b32 v161, v181, v169
    v_and_b32 v162, v182, v170
    v_and_b32 v163, v183, v171
    v_xor_b32 v168, v160, v168
    v_xor_b32 v169, v161, v169
    v_xor_b32 v170, v162, v170
    v_xor_b32 v171, v163, v171
    v_exp_f32 v56, v56
    v_exp_f32 v57, v57
    s_waitcnt lgkmcnt(2)
    v_mfma_f32_32x32x16_bf16 v[144:159], a[248:251], v[160:163], 0
    buffer_load_dwordx4 v15, s[32:35], s45 offen offset:2048 lds
    v_exp_f32 v58, v58
    v_exp_f32 v59, v59
    v_exp_f32 v60, v60
    v_mfma_f32_32x32x16_bf16 v[144:159], a[168:171], v[168:171], v[144:159]
    buffer_load_dwordx4 v16, s[32:35], s45 offen offset:3072 lds
    s_add_u32 s45, s45, 65536
    s_add_u32 m0, s79, 32768
    v_exp_f32 v61, v61
    v_exp_f32 v62, v62
    v_exp_f32 v63, v63
    v_cvt_pk_bf16_f32 v172, v56, v57
    v_cvt_pk_bf16_f32 v173, v58, v59
    v_cvt_pk_bf16_f32 v174, v60, v61
    v_cvt_pk_bf16_f32 v175, v62, v63
    v_and_b32 v164, v184, v172
    v_and_b32 v165, v185, v173
    v_and_b32 v166, v186, v174
    v_and_b32 v167, v187, v175
    v_xor_b32 v172, v164, v172
    v_xor_b32 v173, v165, v173
    v_xor_b32 v174, v166, v174
    v_xor_b32 v175, v167, v175
    s_waitcnt lgkmcnt(0)
    s_barrier
    s_cmp_eq_u32 s57, 8
    s_cbranch_scc1 L_at_n
L_at_n7_back:
    v_mfma_f32_32x32x16_bf16 v[112:127], a[160:163], a[132:135], v[80:95]
    buffer_load_dwordx4 v13, s[32:35], s45 offen offset:0 lds
    v_exp_f32 v96, v96
    v_exp_f32 v97, v97
    v_exp_f32 v98, v98
    v_mfma_f32_32x32x16_bf16 v[144:159], a[252:255], v[164:167], v[144:159]
    buffer_load_dwordx4 v14, s[32:35], s45 offen offset:1024 lds
    v_exp_f32 v99, v99
    v_exp_f32 v100, v100
    v_exp_f32 v101, v101
    v_exp_f32 v102, v102
    v_mfma_f32_32x32x16_bf16 v[144:159], a[172:175], v[172:175], v[144:159]
    v_exp_f32 v103, v103
    v_cvt_pk_bf16_f32 v160, v96, v97
    v_cvt_pk_bf16_f32 v161, v98, v99
    v_cvt_pk_bf16_f32 v162, v100, v101
    v_cvt_pk_bf16_f32 v163, v102, v103
    v_exp_f32 v104, v104
    v_exp_f32 v105, v105
    v_mfma_f32_32x32x16_bf16 v[144:159], a[224:227], v[160:163], v[144:159]
    buffer_load_dwordx4 v15, s[32:35], s45 offen offset:2048 lds
    v_exp_f32 v106, v106
    v_exp_f32 v107, v107
    v_exp_f32 v108, v108
    s_waitcnt vmcnt(28)
    v_mfma_f32_32x32x16_bf16 v[32:47], a[0:3], a[96:99], 0
    buffer_load_dwordx4 v16, s[32:35], s45 offen offset:3072 lds
    v_exp_f32 v109, v109
    v_exp_f32 v110, v110
    v_exp_f32 v111, v111
    v_mfma_f32_32x32x16_bf16 v[48:63], a[0:3], a[100:103], 0
    v_cvt_pk_bf16_f32 v164, v104, v105
    v_cvt_pk_bf16_f32 v165, v106, v107
    v_cvt_pk_bf16_f32 v166, v108, v109
    v_cvt_pk_bf16_f32 v167, v110, v111
    v_mfma_f32_32x32x16_bf16 v[96:111], a[160:163], a[128:131], v[64:79]
    buffer_load_dwordx2 v[190:191], v23, s[28:31], 0 offen sc1
    buffer_load_dwordx4 v[224:227], v1, s[28:31], s58 offen offset:0 sc1
    v_exp_f32 v112, v112
    v_exp_f32 v113, v113
    v_exp_f32 v114, v114
    v_mfma_f32_32x32x16_bf16 v[144:159], a[228:231], v[164:167], v[144:159]
    v_exp_f32 v115, v115
    v_exp_f32 v116, v116
    v_exp_f32 v117, v117
    v_exp_f32 v118, v118
    v_mfma_f32_32x32x16_bf16 v[168:183], a[4:7], a[96:99], 0
    buffer_load_dwordx4 v[228:231], v1, s[28:31], s54 offen offset:0 sc1
    v_exp_f32 v119, v119
    v_cvt_pk_bf16_f32 v160, v112, v113
    v_cvt_pk_bf16_f32 v161, v114, v115
    v_cvt_pk_bf16_f32 v162, v116, v117
    v_cvt_pk_bf16_f32 v163, v118, v119
    v_exp_f32 v120, v120
    v_exp_f32 v121, v121
    v_mfma_f32_32x32x16_bf16 v[144:159], a[216:219], v[160:163], v[144:159]
    v_exp_f32 v122, v122
    v_exp_f32 v123, v123
    v_exp_f32 v124, v124
    v_mfma_f32_32x32x16_bf16 a[240:255], a[4:7], a[100:103], 0
    buffer_load_dwordx4 v[232:235], v1, s[28:31], s58 offen offset:1024 sc1
    v_exp_f32 v125, v125
    v_exp_f32 v126, v126
    v_exp_f32 v127, v127
    v_mfma_f32_32x32x16_bf16 v[32:47], a[8:11], a[104:107], v[32:47]
    v_cvt_pk_bf16_f32 v164, v120, v121
    v_cvt_pk_bf16_f32 v165, v122, v123
    v_cvt_pk_bf16_f32 v166, v124, v125
    v_cvt_pk_bf16_f32 v167, v126, v127
    v_mfma_f32_32x32x16_bf16 v[112:127], a[156:159], a[132:135], v[80:95]
    buffer_load_dwordx4 v[236:239], v1, s[28:31], s54 offen offset:1024 sc1
    v_exp_f32 v96, v96
    v_exp_f32 v97, v97
    v_exp_f32 v98, v98
    v_mfma_f32_32x32x16_bf16 v[144:159], a[220:223], v[164:167], v[144:159]
    v_exp_f32 v99, v99
    v_exp_f32 v100, v100
    v_exp_f32 v101, v101
    v_exp_f32 v102, v102
    v_mfma_f32_32x32x16_bf16 v[48:63], a[8:11], a[108:111], v[48:63]
    buffer_load_dwordx4 v[240:243], v1, s[28:31], s58 offen offset:2048 sc1
    v_exp_f32 v103, v103
    v_cvt_pk_bf16_f32 v160, v96, v97
    v_cvt_pk_bf16_f32 v161, v98, v99
    v_cvt_pk_bf16_f32 v162, v100, v101
    v_cvt_pk_bf16_f32 v163, v102, v103
    v_exp_f32 v104, v104
    v_exp_f32 v105, v105
    v_mfma_f32_32x32x16_bf16 v[128:143], a[216:219], v[160:163], v[128:143]
    v_exp_f32 v106, v106
    v_exp_f32 v107, v107
    v_exp_f32 v108, v108
    v_mfma_f32_32x32x16_bf16 v[168:183], a[12:15], a[104:107], v[168:183]
    buffer_load_dwordx4 v[244:247], v1, s[28:31], s54 offen offset:2048 sc1
    v_exp_f32 v109, v109
    v_exp_f32 v110, v110
    v_exp_f32 v111, v111
    v_mfma_f32_32x32x16_bf16 a[240:255], a[12:15], a[108:111], a[240:255]
    v_cvt_pk_bf16_f32 v164, v104, v105
    v_cvt_pk_bf16_f32 v165, v106, v107
    v_cvt_pk_bf16_f32 v166, v108, v109
    v_cvt_pk_bf16_f32 v167, v110, v111
    v_mfma_f32_32x32x16_bf16 v[96:111], a[156:159], a[128:131], v[64:79]
    buffer_load_dwordx4 v[248:251], v1, s[28:31], s58 offen offset:3072 sc1
    v_exp_f32 v112, v112
    v_exp_f32 v113, v113
    v_exp_f32 v114, v114
    v_mfma_f32_32x32x16_bf16 v[128:143], a[220:223], v[164:167], v[128:143]
    v_exp_f32 v115, v115
    v_exp_f32 v116, v116
    v_exp_f32 v117, v117
    v_exp_f32 v118, v118
    s_waitcnt vmcnt(33)
    v_mfma_f32_32x32x16_bf16 v[32:47], a[16:19], a[112:115], v[32:47]
    buffer_load_dwordx4 v[252:255], v1, s[28:31], s54 offen offset:3072 sc1
    s_add_u32 s58, s58, 4096
    s_add_u32 s54, s54, 4096
    s_add_u32 s45, s45, 32768
    s_add_u32 m0, s79, 0
    v_exp_f32 v119, v119
    v_cvt_pk_bf16_f32 v160, v112, v113
    v_cvt_pk_bf16_f32 v161, v114, v115
    v_cvt_pk_bf16_f32 v162, v116, v117
    v_cvt_pk_bf16_f32 v163, v118, v119
    v_exp_f32 v120, v120
    v_exp_f32 v121, v121
    v_mfma_f32_32x32x16_bf16 v[144:159], a[208:211], v[160:163], v[144:159]
    buffer_load_dwordx4 v13, s[32:35], s45 offen offset:0 lds
    v_exp_f32 v122, v122
    v_exp_f32 v123, v123
    v_exp_f32 v124, v124
    v_mfma_f32_32x32x16_bf16 v[48:63], a[16:19], a[116:119], v[48:63]
    v_exp_f32 v125, v125
    v_exp_f32 v126, v126
    v_exp_f32 v127, v127
    v_mfma_f32_32x32x16_bf16 v[168:183], a[20:23], a[112:115], v[168:183]
    buffer_load_dwordx4 v14, s[32:35], s45 offen offset:1024 lds
    v_cvt_pk_bf16_f32 v164, v120, v121
    v_cvt_pk_bf16_f32 v165, v122, v123
    v_cvt_pk_bf16_f32 v166, v124, v125
    v_cvt_pk_bf16_f32 v167, v126, v127
    s_cmp_eq_u32 s57, 6
    s_cbranch_scc1 L_at_n
L_at_n5_back:
    v_mfma_f32_32x32x16_bf16 v[112:127], a[152:155], a[132:135], v[80:95]
    v_exp_f32 v96, v96
    v_exp_f32 v97, v97
    v_exp_f32 v98, v98
    v_mfma_f32_32x32x16_bf16 v[144:159], a[212:215], v[164:167], v[144:159]
    buffer_load_dwordx4 v15, s[32:35], s45 offen offset:2048 lds
    v_exp_f32 v99, v99
    v_exp_f32 v100, v100
    v_exp_f32 v101, v101
    v_exp_f32 v102, v102
    v_mfma_f32_32x32x16_bf16 a[240:255], a[20:23], a[116:119], a[240:255]
    v_exp_f32 v103, v103
    v_cvt_pk_bf16_f32 v160, v96, v97
    v_cvt_pk_bf16_f32 v161, v98, v99
    v_cvt_pk_bf16_f32 v162, v100, v101
    v_cvt_pk_bf16_f32 v163, v102, v103
    v_exp_f32 v104, v104
    v_exp_f32 v105, v105
    v_mfma_f32_32x32x16_bf16 v[128:143], a[208:211], v[160:163], v[128:143]
    buffer_load_dwordx4 v16, s[32:35], s45 offen offset:3072 lds
    s_sub_u32 s45, s45, 65536
    s_add_u32 m0, s79, 114688
    v_exp_f32 v106, v106
    v_exp_f32 v107, v107
    v_exp_f32 v108, v108
    v_mfma_f32_32x32x16_bf16 v[32:47], a[24:27], a[120:123], v[32:47]
    buffer_load_dwordx4 v13, s[32:35], s45 offen offset:0 lds
    v_exp_f32 v109, v109
    v_exp_f32 v110, v110
    v_exp_f32 v111, v111
    v_mfma_f32_32x32x16_bf16 v[48:63], a[24:27], a[124:127], v[48:63]
    v_cvt_pk_bf16_f32 v164, v104, v105
    v_cvt_pk_bf16_f32 v165, v106, v107
    v_cvt_pk_bf16_f32 v166, v108, v109
    v_cvt_pk_bf16_f32 v167, v110, v111
L_h_chk:
    s_waitcnt vmcnt(13)
    v_cmp_ne_u64 s[46:47], s[60:61], v[190:191]
    s_cmp_lg_u64 s[46:47], 0
    s_cbranch_scc1 L_h_retry
L_h_ok:
    v_mfma_f32_32x32x16_bf16 v[96:111], a[152:155], a[128:131], v[64:79]
    buffer_load_dwordx4 v14, s[32:35], s45 offen offset:1024 lds
    v_exp_f32 v112, v112
    v_exp_f32 v113, v113
    v_exp_f32 v114, v114
    v_mfma_f32_32x32x16_bf16 v[128:143], a[212:215], v[164:167], v[128:143]
    v_exp_f32 v115, v115
    v_exp_f32 v116, v116
    v_exp_f32 v117, v117
    v_exp_f32 v118, v118
    v_mfma_f32_32x32x16_bf16 v[168:183], a[28:31], a[120:123], v[168:183]
    buffer_load_dwordx4 v15, s[32:35], s45 offen offset:2048 lds
    v_exp_f32 v119, v119
    v_cvt_pk_bf16_f32 v160, v112, v113
    v_cvt_pk_bf16_f32 v161, v114, v115
    v_cvt_pk_bf16_f32 v162, v116, v117
    v_cvt_pk_bf16_f32 v163, v118, v119
    v_exp_f32 v120, v120
    v_exp_f32 v121, v121
    v_mfma_f32_32x32x16_bf16 v[144:159], a[200:203], v[160:163], v[144:159]
    v_exp_f32 v122, v122
    v_exp_f32 v123, v123
    v_exp_f32 v124, v124
    v_mfma_f32_32x32x16_bf16 a[240:255], a[28:31], a[124:127], a[240:255]
    buffer_load_dwordx4 v16, s[32:35], s45 offen offset:3072 lds
    v_exp_f32 v125, v125
    v_exp_f32 v126, v126
    v_exp_f32 v127, v127
    v_mfma_f32_32x32x16_bf16 v[32:47], a[32:35], v[192:195], v[32:47]
    v_cvt_pk_bf16_f32 v164, v120, v121
    v_cvt_pk_bf16_f32 v165, v122, v123
    v_cvt_pk_bf16_f32 v166, v124, v125
    v_cvt_pk_bf16_f32 v167, v126, v127
    v_mfma_f32_32x32x16_bf16 v[112:127], a[148:151], a[132:135], v[80:95]
    buffer_load_dword v10, v10, s[28:31], s64 offen offset:4 sc1
    s_lshl1_add_u32 m0, s79, 65536
    s_lshl_b32 s62, s48, 17
    s_add_u32 s62, s62, 0
    v_exp_f32 v96, v96
    v_exp_f32 v97, v97
    v_exp_f32 v98, v98
    v_mfma_f32_32x32x16_bf16 v[144:159], a[204:207], v[164:167], v[144:159]
    v_exp_f32 v99, v99
    v_exp_f32 v100, v100
    v_exp_f32 v101, v101
    v_exp_f32 v102, v102
    v_mfma_f32_32x32x16_bf16 v[48:63], a[32:35], v[196:199], v[48:63]
    buffer_load_dwordx4 v13, s[36:39], s62 offen offset:0 lds
    v_exp_f32 v103, v103
    v_cvt_pk_bf16_f32 v160, v96, v97
    v_cvt_pk_bf16_f32 v161, v98, v99
    v_cvt_pk_bf16_f32 v162, v100, v101
    v_cvt_pk_bf16_f32 v163, v102, v103
    v_exp_f32 v104, v104
    v_exp_f32 v105, v105
    v_mfma_f32_32x32x16_bf16 v[128:143], a[200:203], v[160:163], v[128:143]
    buffer_load_dwordx4 v14, s[36:39], s62 offen offset:1024 lds
    v_exp_f32 v106, v106
    v_exp_f32 v107, v107
    v_exp_f32 v108, v108
    v_mfma_f32_32x32x16_bf16 v[168:183], a[36:39], v[192:195], v[168:183]
    v_exp_f32 v109, v109
    v_exp_f32 v110, v110
    v_exp_f32 v111, v111
    v_mfma_f32_32x32x16_bf16 a[240:255], a[36:39], v[196:199], a[240:255]
    buffer_load_dwordx4 v15, s[36:39], s62 offen offset:2048 lds
    v_cvt_pk_bf16_f32 v164, v104, v105
    v_cvt_pk_bf16_f32 v165, v106, v107
    v_cvt_pk_bf16_f32 v166, v108, v109
    v_cvt_pk_bf16_f32 v167, v110, v111
    v_mfma_f32_32x32x16_bf16 v[96:111], a[148:151], a[128:131], v[64:79]
    v_exp_f32 v112, v112
    v_exp_f32 v113, v113
    v_exp_f32 v114, v114
    v_mfma_f32_32x32x16_bf16 v[128:143], a[204:207], v[164:167], v[128:143]
    buffer_load_dwordx4 v16, s[36:39], s62 offen offset:3072 lds
    v_exp_f32 v115, v115
    v_exp_f32 v116, v116
    v_exp_f32 v117, v117
    v_exp_f32 v118, v118
    v_mfma_f32_32x32x16_bf16 v[32:47], a[40:43], v[200:203], v[32:47]
    v_exp_f32 v119, v119
    v_cvt_pk_bf16_f32 v160, v112, v113
    v_cvt_pk_bf16_f32 v161, v114, v115
    v_cvt_pk_bf16_f32 v162, v116, v117
    v_cvt_pk_bf16_f32 v163, v118, v119
    v_exp_f32 v120, v120
    v_exp_f32 v121, v121
    v_mfma_f32_32x32x16_bf16 v[144:159], a[192:195], v[160:163], v[144:159]
    buffer_load_dwordx4 a[0:3], v1, s[28:31], s65 offen offset:0 sc1
    v_exp_f32 v122, v122
    v_exp_f32 v123, v123
    v_exp_f32 v124, v124
    v_mfma_f32_32x32x16_bf16 v[48:63], a[40:43], v[204:207], v[48:63]
    v_exp_f32 v125, v125
    v_exp_f32 v126, v126
    v_exp_f32 v127, v127
    v_mfma_f32_32x32x16_bf16 v[168:183], a[44:47], v[200:203], v[168:183]
    buffer_load_dwordx4 a[4:7], v1, s[28:31], s66 offen offset:0 sc1
    v_cvt_pk_bf16_f32 v164, v120, v121
    v_cvt_pk_bf16_f32 v165, v122, v123
    v_cvt_pk_bf16_f32 v166, v124, v125
    v_cvt_pk_bf16_f32 v167, v126, v127
    s_cmp_eq_u32 s57, 4
    s_cbranch_scc1 L_at_n
L_at_n3_back:
    v_mfma_f32_32x32x16_bf16 v[112:127], a[144:147], a[132:135], v[80:95]
    v_exp_f32 v96, v96
    v_exp_f32 v97, v97
    v_exp_f32 v98, v98
    v_mfma_f32_32x32x16_bf16 v[144:159], a[196:199], v[164:167], v[144:159]
    buffer_load_dwordx4 a[8:11], v1, s[28:31], s65 offen offset:1024 sc1
    v_exp_f32 v99, v99
    v_exp_f32 v100, v100
    v_exp_f32 v101, v101
    v_exp_f32 v102, v102
    v_mfma_f32_32x32x16_bf16 a[240:255], a[44:47], v[204:207], a[240:255]
    v_exp_f32 v103, v103
    v_cvt_pk_bf16_f32 v160, v96, v97
    v_cvt_pk_bf16_f32 v161, v98, v99
    v_cvt_pk_bf16_f32 v162, v100, v101
    v_cvt_pk_bf16_f32 v163, v102, v103
    v_exp_f32 v104, v104
    v_exp_f32 v105, v105
    v_mfma_f32_32x32x16_bf16 v[128:143], a[192:195], v[160:163], v[128:143]
    buffer_load_dwordx4 a[12:15], v1, s[28:31], s66 offen offset:1024 sc1
    v_exp_f32 v106, v106
    v_exp_f32 v107, v107
    v_exp_f32 v108, v108
    v_mfma_f32_32x32x16_bf16 v[32:47], a[48:51], v[208:211], v[32:47]
    buffer_load_dwordx4 a[96:99], v1, s[28:31], s65 offen offset:2048 sc1
    v_exp_f32 v109, v109
    v_exp_f32 v110, v110
    v_exp_f32 v111, v111
    v_mfma_f32_32x32x16_bf16 v[48:63], a[48:51], v[212:215], v[48:63]
    v_cvt_pk_bf16_f32 v164, v104, v105
    v_cvt_pk_bf16_f32 v165, v106, v107
    v_cvt_pk_bf16_f32 v166, v108, v109
    v_cvt_pk_bf16_f32 v167, v110, v111
    v_mfma_f32_32x32x16_bf16 v[96:111], a[144:147], a[128:131], v[64:79]
    v_exp_f32 v112, v112
    v_exp_f32 v113, v113
    v_exp_f32 v114, v114
    v_mfma_f32_32x32x16_bf16 v[128:143], a[196:199], v[164:167], v[128:143]
    buffer_load_dwordx4 a[100:103], v1, s[28:31], s66 offen offset:2048 sc1
    v_exp_f32 v115, v115
    v_exp_f32 v116, v116
    v_exp_f32 v117, v117
    v_exp_f32 v118, v118
    v_mfma_f32_32x32x16_bf16 v[168:183], a[52:55], v[208:211], v[168:183]
    buffer_load_dwordx4 a[104:107], v1, s[28:31], s65 offen offset:3072 sc1
    v_exp_f32 v119, v119
    v_cvt_pk_bf16_f32 v160, v112, v113
    v_cvt_pk_bf16_f32 v161, v114, v115
    v_cvt_pk_bf16_f32 v162, v116, v117
    v_cvt_pk_bf16_f32 v163, v118, v119
    v_exp_f32 v120, v120
    v_exp_f32 v121, v121
    v_mfma_f32_32x32x16_bf16 v[144:159], a[184:187], v[160:163], v[144:159]
    v_exp_f32 v122, v122
    v_exp_f32 v123, v123
    v_exp_f32 v124, v124
    v_mfma_f32_32x32x16_bf16 a[240:255], a[52:55], v[212:215], a[240:255]
    buffer_load_dwordx4 a[108:111], v1, s[28:31], s66 offen offset:3072 sc1
    s_add_u32 s65, s65, 4096
    s_add_u32 s66, s66, 4096
    v_exp_f32 v125, v125
    v_exp_f32 v126, v126
    v_exp_f32 v127, v127
    v_mfma_f32_32x32x16_bf16 v[32:47], a[56:59], v[216:219], v[32:47]
    v_cvt_pk_bf16_f32 v164, v120, v121
    v_cvt_pk_bf16_f32 v165, v122, v123
    v_cvt_pk_bf16_f32 v166, v124, v125
    v_cvt_pk_bf16_f32 v167, v126, v127
    v_mfma_f32_32x32x16_bf16 v[112:127], a[140:143], a[132:135], v[80:95]
    buffer_load_dwordx4 a[16:19], v1, s[28:31], s65 offen offset:0 sc1
    v_exp_f32 v96, v96
    v_exp_f32 v97, v97
    v_exp_f32 v98, v98
    v_mfma_f32_32x32x16_bf16 v[144:159], a[188:191], v[164:167], v[144:159]
    v_exp_f32 v99, v99
    v_exp_f32 v100, v100
    v_exp_f32 v101, v101
    v_exp_f32 v102, v102
    v_mfma_f32_32x32x16_bf16 v[48:63], a[56:59], v[220:223], v[48:63]
    buffer_load_dwordx4 a[20:23], v1, s[28:31], s66 offen offset:0 sc1
    v_exp_f32 v103, v103
    v_cvt_pk_bf16_f32 v160, v96, v97
    v_cvt_pk_bf16_f32 v161, v98, v99
    v_cvt_pk_bf16_f32 v162, v100, v101
    v_cvt_pk_bf16_f32 v163, v102, v103
    v_exp_f32 v104, v104
    v_exp_f32 v105, v105
    v_mfma_f32_32x32x16_bf16 v[128:143], a[184:187], v[160:163], v[128:143]
    buffer_load_dwordx4 a[24:27], v1, s[28:31], s65 offen offset:1024 sc1
    v_exp_f32 v106, v106
    v_exp_f32 v107, v107
    v_exp_f32 v108, v108
    v_mfma_f32_32x32x16_bf16 v[168:183], a[60:63], v[216:219], v[168:183]
    v_exp_f32 v109, v109
    v_exp_f32 v110, v110
    v_exp_f32 v111, v111
    v_mfma_f32_32x32x16_bf16 a[240:255], a[60:63], v[220:223], a[240:255]
    v_cvt_pk_bf16_f32 v164, v104, v105
    v_cvt_pk_bf16_f32 v165, v106, v107
    v_cvt_pk_bf16_f32 v166, v108, v109
    v_cvt_pk_bf16_f32 v167, v110, v111
    v_mfma_f32_32x32x16_bf16 v[96:111], a[140:143], a[128:131], v[64:79]
    buffer_load_dwordx4 a[28:31], v1, s[28:31], s66 offen offset:1024 sc1
    v_exp_f32 v112, v112
    v_exp_f32 v113, v113
    v_exp_f32 v114, v114
    v_mfma_f32_32x32x16_bf16 v[128:143], a[188:191], v[164:167], v[128:143]
    v_exp_f32 v115, v115
    v_exp_f32 v116, v116
    v_exp_f32 v117, v117
    v_exp_f32 v118, v118
    s_waitcnt vmcnt(29)
    v_mfma_f32_32x32x16_bf16 v[32:47], a[64:67], v[224:227], v[32:47]
    buffer_load_dwordx4 a[112:115], v1, s[28:31], s65 offen offset:2048 sc1
    v_exp_f32 v119, v119
    v_cvt_pk_bf16_f32 v160, v112, v113
    v_cvt_pk_bf16_f32 v161, v114, v115
    v_cvt_pk_bf16_f32 v162, v116, v117
    v_cvt_pk_bf16_f32 v163, v118, v119
    v_exp_f32 v120, v120
    v_exp_f32 v121, v121
    v_mfma_f32_32x32x16_bf16 v[144:159], a[176:179], v[160:163], v[144:159]
    buffer_load_dwordx4 a[116:119], v1, s[28:31], s66 offen offset:2048 sc1
    v_exp_f32 v122, v122
    v_exp_f32 v123, v123
    v_exp_f32 v124, v124
    v_mfma_f32_32x32x16_bf16 v[48:63], a[64:67], v[228:231], v[48:63]
    v_exp_f32 v125, v125
    v_exp_f32 v126, v126
    v_exp_f32 v127, v127
    v_mfma_f32_32x32x16_bf16 v[168:183], a[68:71], v[224:227], v[168:183]
    buffer_load_dwordx4 a[120:123], v1, s[28:31], s65 offen offset:3072 sc1
    v_cvt_pk_bf16_f32 v164, v120, v121
    v_cvt_pk_bf16_f32 v165, v122, v123
    v_cvt_pk_bf16_f32 v166, v124, v125
    v_cvt_pk_bf16_f32 v167, v126, v127
    s_cmp_eq_u32 s57, 2
    s_cbranch_scc1 L_at_n
L_at_n1_back:
    v_mfma_f32_32x32x16_bf16 v[112:127], a[136:139], a[128:131], v[64:79]
    v_exp_f32 v96, v96
    v_exp_f32 v97, v97
    v_exp_f32 v98, v98
    v_mfma_f32_32x32x16_bf16 v[144:159], a[180:183], v[164:167], v[144:159]
    buffer_load_dwordx4 a[124:127], v1, s[28:31], s66 offen offset:3072 sc1
    s_add_u32 s65, s65, 4096
    s_add_u32 s66, s66, 4096
    v_exp_f32 v99, v99
    v_exp_f32 v100, v100
    v_exp_f32 v101, v101
    v_exp_f32 v102, v102
    v_mfma_f32_32x32x16_bf16 a[240:255], a[68:71], v[228:231], a[240:255]
    v_exp_f32 v103, v103
    v_cvt_pk_bf16_f32 v160, v96, v97
    v_cvt_pk_bf16_f32 v161, v98, v99
    v_cvt_pk_bf16_f32 v162, v100, v101
    v_cvt_pk_bf16_f32 v163, v102, v103
    v_exp_f32 v104, v104
    v_exp_f32 v105, v105
    v_mfma_f32_32x32x16_bf16 v[128:143], a[176:179], v[160:163], v[128:143]
    buffer_load_dwordx4 a[32:35], v1, s[28:31], s65 offen offset:0 sc1
    v_exp_f32 v106, v106
    v_exp_f32 v107, v107
    v_exp_f32 v108, v108
    v_mfma_f32_32x32x16_bf16 v[32:47], a[72:75], v[232:235], v[32:47]
    v_exp_f32 v109, v109
    v_exp_f32 v110, v110
    v_exp_f32 v111, v111
    v_mfma_f32_32x32x16_bf16 v[48:63], a[72:75], v[236:239], v[48:63]
    buffer_load_dwordx4 a[36:39], v1, s[28:31], s66 offen offset:0 sc1
    v_cvt_pk_bf16_f32 v164, v104, v105
    v_cvt_pk_bf16_f32 v165, v106, v107
    v_cvt_pk_bf16_f32 v166, v108, v109
    v_cvt_pk_bf16_f32 v167, v110, v111
    v_rcp_f32 v152, v152
    s_add_u32 s56, s56, 32768
    v_mul_f32 v144, v152, v144
    v_mul_f32 v145, v152, v145
    v_mul_f32 v146, v152, v146
    v_mul_f32 v147, v152, v147
    v_mfma_f32_32x32x16_bf16 v[168:183], a[76:79], v[232:235], v[168:183]
    buffer_load_dwordx4 a[40:43], v1, s[28:31], s65 offen offset:1024 sc1
    v_mul_f32 v148, v152, v148
    v_mul_f32 v149, v152, v149
    v_mul_f32 v150, v152, v150
    v_mul_f32 v151, v152, v151
    v_cvt_pk_bf16_f32 v144, v144, v145
    v_cvt_pk_bf16_f32 v145, v146, v147
    v_cvt_pk_bf16_f32 v146, v148, v149
    v_cvt_pk_bf16_f32 v147, v150, v151
    buffer_store_dwordx4 v[144:147], v1, s[28:31], s56 offen sc1
    v_mfma_f32_32x32x16_bf16 a[240:255], a[76:79], v[236:239], a[240:255]
    v_exp_f32 v112, v112
    v_exp_f32 v113, v113
    v_exp_f32 v114, v114
    v_mfma_f32_32x32x16_bf16 v[128:143], a[180:183], v[164:167], v[128:143]
    buffer_load_dwordx4 a[44:47], v1, s[28:31], s66 offen offset:1024 sc1
    v_exp_f32 v115, v115
    v_exp_f32 v116, v116
    v_exp_f32 v117, v117
    v_exp_f32 v118, v118
    s_waitcnt vmcnt(34)
    v_mfma_f32_32x32x16_bf16 v[32:47], a[80:83], v[240:243], v[32:47]
    v_exp_f32 v119, v119
    v_cvt_pk_bf16_f32 v160, v112, v113
    v_cvt_pk_bf16_f32 v161, v114, v115
    v_cvt_pk_bf16_f32 v162, v116, v117
    v_cvt_pk_bf16_f32 v163, v118, v119
    v_exp_f32 v120, v120
    v_exp_f32 v121, v121
    v_mfma_f32_32x32x16_bf16 v[128:143], a[168:171], v[160:163], v[128:143]
    v_exp_f32 v122, v122
    v_exp_f32 v123, v123
    v_exp_f32 v124, v124
    v_mfma_f32_32x32x16_bf16 v[48:63], a[80:83], v[244:247], v[48:63]
    v_exp_f32 v125, v125
    v_exp_f32 v126, v126
    v_exp_f32 v127, v127
    v_mfma_f32_32x32x16_bf16 v[168:183], a[84:87], v[240:243], v[168:183]
    v_cvt_pk_bf16_f32 v164, v120, v121
    v_cvt_pk_bf16_f32 v165, v122, v123
    v_cvt_pk_bf16_f32 v166, v124, v125
    v_cvt_pk_bf16_f32 v167, v126, v127
    s_nop 1
    v_mfma_f32_32x32x16_bf16 v[128:143], a[172:175], v[164:167], v[128:143]
    v_mfma_f32_32x32x16_bf16 a[240:255], a[84:87], v[244:247], a[240:255]
    s_nop 10
    v_rcp_f32 v136, v136
    s_sub_u32 s56, s56, 32768
    v_mul_f32 v128, v136, v128
    v_mul_f32 v129, v136, v129
    v_mul_f32 v130, v136, v130
    v_mul_f32 v131, v136, v131
    v_mul_f32 v132, v136, v132
    v_mul_f32 v133, v136, v133
    v_mul_f32 v134, v136, v134
    v_mul_f32 v135, v136, v135
    v_cvt_pk_bf16_f32 v128, v128, v129
    v_cvt_pk_bf16_f32 v129, v130, v131
    v_cvt_pk_bf16_f32 v130, v132, v133
    v_cvt_pk_bf16_f32 v131, v134, v135
    buffer_store_dwordx4 v[128:131], v1, s[28:31], s56 offen sc1
    v_mfma_f32_32x32x16_bf16 v[32:47], a[88:91], v[248:251], v[32:47]
    ds_read_b64_tr_b16 v[96:97], v18 offset:16384
    ds_read_b64_tr_b16 v[98:99], v18 offset:17408
    buffer_load_dwordx4 v[196:199], v1, s[28:31], s66 offen offset:2048 sc1
    v_add_u32 v144, s79, v1
    v_add_u32 v145, 98304, v144
    v_xor_b32 v146, 4096, v144
    v_mfma_f32_32x32x16_bf16 v[48:63], a[88:91], v[252:255], v[48:63]
    buffer_load_dwordx4 v[204:207], v1, s[28:31], s66 offen offset:3072 sc1
    s_add_u32 s66, s66, 4096
    v_add_u32 v146, 98304, v146
    v_xor_b32 v147, 8192, v144
    v_xor_b32 v148, 12288, v144
    v_add_u32 v148, 98304, v148
    v_mfma_f32_32x32x16_bf16 v[168:183], a[92:95], v[248:251], v[168:183]
    ds_read_b64_tr_b16 v[100:101], v19 offset:16384
    ds_read_b64_tr_b16 v[102:103], v19 offset:17408
    buffer_load_dwordx4 a[52:55], v1, s[28:31], s66 offen offset:0 sc1
    v_add_u32 v149, 98304, v147
    v_subrev_u32 v150, s79, v18
    v_lshrrev_b32 v154, 5, v0
    v_mfma_f32_32x32x16_bf16 a[240:255], a[92:95], v[252:255], a[240:255]
    v_lshl_add_u32 v150, v154, 9, v150
    s_lshl_b32 s82, s50, 13
    v_add_u32 v152, s82, v150
    s_lshl_b32 s82, s50, 14
    s_add_u32 s82, s82, 65536
    v_add_u32 v150, s82, v150
    s_waitcnt vmcnt(24) lgkmcnt(2)
    v_mfma_f32_32x32x16_bf16 v[32:47], v[96:99], a[0:3], v[32:47]
    ds_read_b64_tr_b16 v[104:105], v18 offset:18432
    ds_read_b64_tr_b16 v[106:107], v18 offset:19456
    buffer_load_dwordx4 a[60:63], v1, s[28:31], s66 offen offset:1024 sc1
    v_xor_b32 v151, 64, v150
    v_xor_b32 v153, 64, v152
    s_lshl_b32 s82, s48, 15
    s_waitcnt vmcnt(24)
    v_mfma_f32_32x32x16_bf16 v[48:63], v[96:99], a[4:7], v[48:63]
    s_add_u32 s82, s82, 131072
    s_cmp_eq_u32 s2, 0
    s_cselect_b32 s82, s82, 0x40000000
    v_lshl_add_u32 v26, v0, 9, s82
    s_or_b32 s82, s2, s48
    s_cmp_eq_u32 s82, 0
    s_cselect_b32 s82, 0, 0x40000000
    s_waitcnt lgkmcnt(2)
    v_mfma_f32_32x32x16_bf16 v[168:183], v[100:103], a[0:3], v[168:183]
    ds_read_b64_tr_b16 v[108:109], v19 offset:18432
    ds_read_b64_tr_b16 v[110:111], v19 offset:19456
    buffer_load_dwordx4 v[212:215], v1, s[28:31], s66 offen offset:2048 sc1
    v_or_b32 v27, s82, v17
    v_mfma_f32_32x32x16_bf16 a[240:255], v[100:103], a[4:7], a[240:255]
    buffer_load_dwordx2 v[28:29], v26, s[28:31], 0 offen sc1
    s_waitcnt vmcnt(25) lgkmcnt(2)
    v_mfma_f32_32x32x16_bf16 v[32:47], v[104:107], a[8:11], v[32:47]
    ds_read_b64_tr_b16 v[96:97], v18 offset:49152
    ds_read_b64_tr_b16 v[98:99], v18 offset:50176
    buffer_load_dwordx4 v[220:223], v1, s[28:31], s66 offen offset:3072 sc1
    s_add_u32 s66, s66, 4096
    s_waitcnt vmcnt(25)
    v_mfma_f32_32x32x16_bf16 v[48:63], v[104:107], a[12:15], v[48:63]
    s_waitcnt lgkmcnt(2)
    v_mfma_f32_32x32x16_bf16 v[168:183], v[108:111], a[8:11], v[168:183]
    ds_read_b64_tr_b16 v[100:101], v19 offset:49152
    ds_read_b64_tr_b16 v[102:103], v19 offset:50176
    s_add_u32 s44, s44, 0x20000
    s_waitcnt vmcnt(7)
    buffer_store_dwordx2 v[188:189], v17, s[28:31], s44 offen sc1
    buffer_load_dwordx4 v[192:195], v1, s[28:31], s65 offen offset:2048 sc1
    v_mfma_f32_32x32x16_bf16 a[240:255], v[108:111], a[12:15], a[240:255]
    s_waitcnt lgkmcnt(2)
    v_mfma_f32_32x32x16_bf16 v[32:47], v[96:99], a[96:99], v[32:47]
    ds_read_b64_tr_b16 v[104:105], v18 offset:51200
    ds_read_b64_tr_b16 v[106:107], v18 offset:52224
    buffer_load_dwordx4 v[200:203], v1, s[28:31], s65 offen offset:3072 sc1
    s_add_u32 s65, s65, 4096
    v_mfma_f32_32x32x16_bf16 v[48:63], v[96:99], a[100:103], v[48:63]
    s_waitcnt lgkmcnt(2)
    v_mfma_f32_32x32x16_bf16 v[168:183], v[100:103], a[96:99], v[168:183]
    ds_read_b64_tr_b16 v[108:109], v19 offset:51200
    ds_read_b64_tr_b16 v[110:111], v19 offset:52224
    buffer_load_dwordx4 a[48:51], v1, s[28:31], s65 offen offset:0 sc1
    v_mfma_f32_32x32x16_bf16 a[240:255], v[100:103], a[100:103], a[240:255]
    s_waitcnt lgkmcnt(2)
    v_mfma_f32_32x32x16_bf16 v[32:47], v[104:107], a[104:107], v[32:47]
    ds_read_b64_tr_b16 v[96:97], v20 offset:0
    ds_read_b64_tr_b16 v[98:99], v20 offset:1024
    buffer_load_dwordx4 a[56:59], v1, s[28:31], s65 offen offset:1024 sc1
    v_mfma_f32_32x32x16_bf16 v[48:63], v[104:107], a[108:111], v[48:63]
    s_waitcnt lgkmcnt(2)
    v_mfma_f32_32x32x16_bf16 v[168:183], v[108:111], a[104:107], v[168:183]
    ds_read_b64_tr_b16 v[100:101], v21 offset:0
    ds_read_b64_tr_b16 v[102:103], v21 offset:1024
    buffer_load_dwordx4 v[208:211], v1, s[28:31], s65 offen offset:2048 sc1
    v_mfma_f32_32x32x16_bf16 a[240:255], v[108:111], a[108:111], a[240:255]
    s_waitcnt lgkmcnt(2)
    v_mfma_f32_32x32x16_bf16 v[32:47], v[96:99], a[16:19], v[32:47]
    ds_read_b64_tr_b16 v[104:105], v20 offset:2048
    ds_read_b64_tr_b16 v[106:107], v20 offset:3072
    buffer_load_dwordx4 v[216:219], v1, s[28:31], s65 offen offset:3072 sc1
    s_add_u32 s65, s65, 4096
    s_lshl1_add_u32 m0, s79, 69632
    s_lshl_b32 s62, s48, 17
    v_mfma_f32_32x32x16_bf16 v[48:63], v[96:99], a[20:23], v[48:63]
    s_add_u32 s62, s62, 32768
    s_waitcnt lgkmcnt(2)
    v_mfma_f32_32x32x16_bf16 v[168:183], v[100:103], a[16:19], v[168:183]
    ds_read_b64_tr_b16 v[108:109], v21 offset:2048
    ds_read_b64_tr_b16 v[110:111], v21 offset:3072
    buffer_load_dwordx4 v13, s[36:39], s62 offen offset:0 lds
    v_mfma_f32_32x32x16_bf16 a[240:255], v[100:103], a[20:23], a[240:255]
    s_waitcnt lgkmcnt(2)
    v_mfma_f32_32x32x16_bf16 v[32:47], v[104:107], a[24:27], v[32:47]
    ds_read_b64_tr_b16 v[96:97], v20 offset:32768
    ds_read_b64_tr_b16 v[98:99], v20 offset:33792
    buffer_load_dwordx4 v14, s[36:39], s62 offen offset:1024 lds
    v_permlane16_swap_b32 v2, v6
    v_permlane16_swap_b32 v3, v7
    v_permlane16_swap_b32 v4, v8
    v_mfma_f32_32x32x16_bf16 v[48:63], v[104:107], a[28:31], v[48:63]
    v_permlane16_swap_b32 v5, v9
    v_mul_f32 v10, v10, v10
    v_mul_f32 v154, 0xbfb8aa3b, v10
    v_rcp_f32 v156, v10
    v_permlane32_swap_b32 v2, v4
    s_waitcnt lgkmcnt(2)
    v_mfma_f32_32x32x16_bf16 v[168:183], v[108:111], a[24:27], v[168:183]
    ds_read_b64_tr_b16 v[100:101], v21 offset:32768
    ds_read_b64_tr_b16 v[102:103], v21 offset:33792
    buffer_load_dwordx4 v15, s[36:39], s62 offen offset:2048 lds
    v_permlane32_swap_b32 v3, v5
    v_permlane32_swap_b32 v6, v8
    v_permlane32_swap_b32 v7, v9
    v_mfma_f32_32x32x16_bf16 a[240:255], v[108:111], a[28:31], a[240:255]
    v_lshlrev_b32 v128, 16, v2
    v_and_b32 v129, 0xffff0000, v2
    v_lshlrev_b32 v130, 16, v3
    v_and_b32 v131, 0xffff0000, v3
    v_lshlrev_b32 v132, 16, v4
    v_and_b32 v133, 0xffff0000, v4
    s_waitcnt lgkmcnt(2)
    v_mfma_f32_32x32x16_bf16 v[32:47], v[96:99], a[112:115], v[32:47]
    ds_read_b64_tr_b16 v[104:105], v20 offset:34816
    ds_read_b64_tr_b16 v[106:107], v20 offset:35840
    buffer_load_dwordx4 v16, s[36:39], s62 offen offset:3072 lds
    s_add_u32 m0, s79, 16384
    s_lshl_b32 s62, s48, 17
    s_add_u32 s62, s62, 65536
    v_mfma_f32_32x32x16_bf16 v[48:63], v[96:99], a[116:119], v[48:63]
    v_lshlrev_b32 v134, 16, v5
    v_and_b32 v135, 0xffff0000, v5
    v_lshlrev_b32 v136, 16, v6
    v_and_b32 v137, 0xffff0000, v6
    v_lshlrev_b32 v138, 16, v7
    v_and_b32 v139, 0xffff0000, v7
    s_waitcnt lgkmcnt(2)
    v_mfma_f32_32x32x16_bf16 v[168:183], v[100:103], a[112:115], v[168:183]
    ds_read_b64_tr_b16 v[108:109], v21 offset:34816
    ds_read_b64_tr_b16 v[110:111], v21 offset:35840
    buffer_load_dwordx4 v13, s[36:39], s62 offen offset:0 lds
    v_lshlrev_b32 v140, 16, v8
    v_and_b32 v141, 0xffff0000, v8
    v_lshlrev_b32 v142, 16, v9
    v_mfma_f32_32x32x16_bf16 a[240:255], v[100:103], a[116:119], a[240:255]
    v_and_b32 v143, 0xffff0000, v9
    s_waitcnt lgkmcnt(2)
    v_mfma_f32_32x32x16_bf16 v[32:47], v[104:107], a[120:123], v[32:47]
    ds_read_b64_tr_b16 v[96:97], v20 offset:49152
    ds_read_b64_tr_b16 v[98:99], v20 offset:50176
    buffer_load_dwordx4 v14, s[36:39], s62 offen offset:1024 lds
    v_mfma_f32_32x32x16_bf16 v[48:63], v[104:107], a[124:127], v[48:63]
    s_waitcnt lgkmcnt(2)
    v_mfma_f32_32x32x16_bf16 v[168:183], v[108:111], a[120:123], v[168:183]
    ds_read_b64_tr_b16 v[100:101], v21 offset:49152
    ds_read_b64_tr_b16 v[102:103], v21 offset:50176
    buffer_load_dwordx4 v15, s[36:39], s62 offen offset:2048 lds
    v_mfma_f32_32x32x16_bf16 a[240:255], v[108:111], a[124:127], a[240:255]
    s_waitcnt lgkmcnt(2)
    v_mfma_f32_32x32x16_bf16 v[32:47], v[96:99], a[32:35], v[32:47]
    ds_read_b64_tr_b16 v[104:105], v20 offset:51200
    ds_read_b64_tr_b16 v[106:107], v20 offset:52224
    buffer_load_dwordx4 v16, s[36:39], s62 offen offset:3072 lds
    s_add_u32 m0, s79, 49152
    s_lshl_b32 s62, s48, 17
    s_add_u32 s62, s62, 98304
    v_mfma_f32_32x32x16_bf16 v[48:63], v[96:99], a[36:39], v[48:63]
    s_waitcnt lgkmcnt(2)
    v_mfma_f32_32x32x16_bf16 v[168:183], v[100:103], a[32:35], v[168:183]
    ds_read_b64_tr_b16 v[108:109], v21 offset:51200
    ds_read_b64_tr_b16 v[110:111], v21 offset:52224
    buffer_load_dwordx4 v13, s[36:39], s62 offen offset:0 lds
    v_mfma_f32_32x32x16_bf16 a[240:255], v[100:103], a[36:39], a[240:255]
    s_waitcnt lgkmcnt(2)
    v_mfma_f32_32x32x16_bf16 v[32:47], v[104:107], a[40:43], v[32:47]
    ds_read_b64_tr_b16 v[64:65], v21 offset:16384
    ds_read_b64_tr_b16 v[66:67], v21 offset:17408
    buffer_load_dwordx4 v14, s[36:39], s62 offen offset:1024 lds
    v_mfma_f32_32x32x16_bf16 v[48:63], v[104:107], a[44:47], v[48:63]
    ds_read_b64_tr_b16 v[68:69], v21 offset:18432
    ds_read_b64_tr_b16 v[70:71], v21 offset:19456
    s_waitcnt lgkmcnt(4)
    v_mfma_f32_32x32x16_bf16 v[168:183], v[108:111], a[40:43], v[168:183]
    ds_read_b64_tr_b16 v[72:73], v19 offset:32768
    ds_read_b64_tr_b16 v[74:75], v19 offset:33792
    buffer_load_dwordx4 v15, s[36:39], s62 offen offset:2048 lds
    v_mfma_f32_32x32x16_bf16 a[240:255], v[108:111], a[44:47], a[240:255]
    ds_read_b64_tr_b16 v[76:77], v19 offset:34816
    ds_read_b64_tr_b16 v[78:79], v19 offset:35840
    s_waitcnt vmcnt(24) lgkmcnt(6)
    v_mfma_f32_32x32x16_bf16 a[240:255], v[64:67], v[196:199], a[240:255]
    ds_read_b64_tr_b16 v[80:81], v19 offset:0
    ds_read_b64_tr_b16 v[82:83], v19 offset:1024
    buffer_load_dwordx4 v16, s[36:39], s62 offen offset:3072 lds
    s_waitcnt vmcnt(24) lgkmcnt(6)
    v_mfma_f32_32x32x16_bf16 a[240:255], v[68:71], v[204:207], a[240:255]
    ds_read_b64_tr_b16 v[84:85], v19 offset:2048
    ds_read_b64_tr_b16 v[86:87], v19 offset:3072
    s_waitcnt vmcnt(23) lgkmcnt(6)
    v_mfma_f32_32x32x16_bf16 a[240:255], v[72:75], a[52:55], a[240:255]
    ds_read_b64_tr_b16 a[192:193], v20 offset:16384
    ds_read_b64_tr_b16 a[194:195], v20 offset:17408
    s_waitcnt vmcnt(22) lgkmcnt(6)
    v_mfma_f32_32x32x16_bf16 a[240:255], v[76:79], a[60:63], a[240:255]
    ds_read_b64_tr_b16 a[196:197], v20 offset:18432
    ds_read_b64_tr_b16 a[198:199], v20 offset:19456
    s_waitcnt vmcnt(21) lgkmcnt(6)
    v_mfma_f32_32x32x16_bf16 a[240:255], v[80:83], v[212:215], a[240:255]
    ds_read_b64_tr_b16 a[200:201], v18 offset:32768
    ds_read_b64_tr_b16 a[202:203], v18 offset:33792
    s_waitcnt vmcnt(19) lgkmcnt(6)
    v_mfma_f32_32x32x16_bf16 a[240:255], v[84:87], v[220:223], a[240:255]
    ds_read_b64_tr_b16 a[204:205], v18 offset:34816
    ds_read_b64_tr_b16 a[206:207], v18 offset:35840
    s_waitcnt lgkmcnt(6)
    v_mfma_f32_32x32x16_bf16 v[48:63], a[192:195], v[196:199], v[48:63]
    ds_read_b64_tr_b16 a[208:209], v18 offset:0
    ds_read_b64_tr_b16 a[210:211], v18 offset:1024
    buffer_load_dwordx2 v[190:191], v24, s[28:31], 0 offen sc1
    s_waitcnt lgkmcnt(6)
    v_mfma_f32_32x32x16_bf16 v[48:63], a[196:199], v[204:207], v[48:63]
    ds_read_b64_tr_b16 a[212:213], v18 offset:2048
    ds_read_b64_tr_b16 a[214:215], v18 offset:3072
    s_waitcnt lgkmcnt(6)
    v_mfma_f32_32x32x16_bf16 v[48:63], a[200:203], a[52:55], v[48:63]
    ds_write_b128 v145, a[240:243] offset:0
    s_waitcnt lgkmcnt(5)
    v_mfma_f32_32x32x16_bf16 v[48:63], a[204:207], a[60:63], v[48:63]
    ds_write_b128 v145, a[244:247] offset:1024
    s_waitcnt lgkmcnt(4)
    v_mfma_f32_32x32x16_bf16 v[48:63], a[208:211], v[212:215], v[48:63]
    ds_write_b128 v145, a[248:251] offset:2048
    s_waitcnt lgkmcnt(3)
    v_mfma_f32_32x32x16_bf16 v[48:63], a[212:215], v[220:223], v[48:63]
    ds_write_b128 v145, a[252:255] offset:3072
    s_waitcnt vmcnt(18)
    v_mfma_f32_32x32x16_bf16 v[168:183], v[64:67], v[192:195], v[168:183]
    s_waitcnt vmcnt(17)
    v_mfma_f32_32x32x16_bf16 v[168:183], v[68:71], v[200:203], v[168:183]
    s_waitcnt vmcnt(16)
    v_mfma_f32_32x32x16_bf16 v[168:183], v[72:75], a[48:51], v[168:183]
    s_nop 4
    ds_write_b128 v145, v[48:51] offset:32768
    buffer_load_dwordx2 v[186:187], v24, s[28:31], 0 offen sc1
    s_waitcnt vmcnt(16)
    v_mfma_f32_32x32x16_bf16 v[168:183], v[76:79], a[56:59], v[168:183]
    ds_write_b128 v145, v[52:55] offset:33792
    s_waitcnt vmcnt(15)
    v_mfma_f32_32x32x16_bf16 v[168:183], v[80:83], v[208:211], v[168:183]
    ds_write_b128 v145, v[56:59] offset:34816
    s_waitcnt vmcnt(14)
    v_mfma_f32_32x32x16_bf16 v[168:183], v[84:87], v[216:219], v[168:183]
    ds_write_b128 v145, v[60:63] offset:35840
    v_mfma_f32_32x32x16_bf16 v[32:47], a[192:195], v[192:195], v[32:47]
    v_mfma_f32_32x32x16_bf16 v[32:47], a[196:199], v[200:203], v[32:47]
    s_waitcnt vmcnt(1)
    v_cmp_ne_u64 s[46:47], s[60:61], v[190:191]
    s_cmp_lg_u64 s[46:47], 0
    s_cbranch_scc1 L_o_retry
L_o_ok:
    v_mfma_f32_32x32x16_bf16 v[32:47], a[200:203], a[48:51], v[32:47]
    s_nop 3
    ds_write_b128 v145, v[168:171] offset:49152
    buffer_load_dwordx4 a[128:131], v1, s[28:31], s78 offen offset:0 sc1
    v_cmp_ne_u64 s[84:85], s[60:61], v[28:29]
    s_cmp_eq_u32 s2, 0
    s_cbranch_scc1 L_bump
L_bump_back:
    v_mfma_f32_32x32x16_bf16 v[32:47], a[204:207], a[56:59], v[32:47]
    ds_write_b128 v145, v[172:175] offset:50176
    buffer_load_dwordx4 a[132:135], v1, s[28:31], s78 offen offset:1024 sc1
    v_mfma_f32_32x32x16_bf16 v[32:47], a[208:211], v[208:211], v[32:47]
    ds_write_b128 v145, v[176:179] offset:51200
    buffer_load_dwordx4 a[136:139], v1, s[28:31], s78 offen offset:2048 sc1
    v_mfma_f32_32x32x16_bf16 v[32:47], a[212:215], v[216:219], v[32:47]
    ds_write_b128 v145, v[180:183] offset:52224
    buffer_load_dwordx4 a[140:143], v1, s[28:31], s78 offen offset:3072 sc1
    s_add_u32 s78, s78, 4096
    s_waitcnt lgkmcnt(0)
    s_barrier
    buffer_store_dword v188, v27, s[28:31], 0 offen sc1
    buffer_load_dwordx4 a[144:147], v1, s[28:31], s78 offen offset:0 sc1
    ds_read_b64_tr_b16 a[4:5], v151 offset:0
    buffer_load_dwordx4 a[148:151], v1, s[28:31], s78 offen offset:1024 sc1
    ds_read_b64_tr_b16 a[6:7], v151 offset:512
    ds_read_b64_tr_b16 a[0:1], v150 offset:0
    ds_read_b64_tr_b16 a[2:3], v150 offset:512
    ds_read_b64_tr_b16 a[12:13], v151 offset:2048
    ds_read_b64_tr_b16 a[14:15], v151 offset:2560
    ds_read_b64_tr_b16 a[8:9], v150 offset:2048
    ds_read_b64_tr_b16 a[10:11], v150 offset:2560
    ds_read_b64_tr_b16 a[20:21], v151 offset:4096
    ds_read_b64_tr_b16 a[22:23], v151 offset:4608
    buffer_load_dwordx4 a[152:155], v1, s[28:31], s78 offen offset:2048 sc1
    ds_read_b64_tr_b16 a[16:17], v150 offset:4096
    ds_read_b64_tr_b16 a[18:19], v150 offset:4608
    ds_read_b128 v[80:83], v148 offset:0
    ds_read_b128 v[48:51], v146 offset:32768
    ds_read_b128 v[64:67], v149 offset:49152
    s_waitcnt vmcnt(7) lgkmcnt(13)
    v_mfma_f32_32x32x16_bf16 v[176:191], a[4:7], a[128:131], 0
    ds_read_b64_tr_b16 a[28:29], v151 offset:6144
    ds_read_b64_tr_b16 a[30:31], v151 offset:6656
    s_waitcnt lgkmcnt(8)
    ds_read_b128 v[84:87], v148 offset:1024
    buffer_load_dwordx4 a[156:159], v1, s[28:31], s78 offen offset:3072 sc1
    s_add_u32 s78, s78, 4096
    v_mfma_f32_32x32x16_bf16 v[160:175], a[0:3], a[128:131], 0
    ds_read_b64_tr_b16 a[24:25], v150 offset:6144
    ds_read_b64_tr_b16 a[26:27], v150 offset:6656
    ds_read_b128 v[52:55], v146 offset:33792
    s_waitcnt vmcnt(7)
    v_mfma_f32_32x32x16_bf16 v[176:191], a[12:15], a[132:135], v[176:191]
    ds_read_b64_tr_b16 a[36:37], v153 offset:16384
    ds_read_b64_tr_b16 a[38:39], v153 offset:16896
    ds_read_b128 v[68:71], v149 offset:50176
    buffer_load_dwordx4 a[160:163], v1, s[28:31], s78 offen offset:0 sc1
    s_waitcnt lgkmcnt(11)
    v_add_f32 v32, v32, v80
    v_add_f32 v33, v33, v81
    v_mfma_f32_32x32x16_bf16 v[160:175], a[8:11], a[132:135], v[160:175]
    ds_read_b64_tr_b16 a[32:33], v152 offset:16384
    ds_read_b64_tr_b16 a[34:35], v152 offset:16896
    ds_read_b128 v[88:91], v148 offset:2048
    buffer_load_dwordx4 a[164:167], v1, s[28:31], s78 offen offset:1024 sc1
    v_add_f32 v34, v34, v82
    v_add_f32 v35, v35, v83
    s_waitcnt vmcnt(8)
    v_mfma_f32_32x32x16_bf16 v[176:191], a[20:23], a[136:139], v[176:191]
    ds_read_b64_tr_b16 a[44:45], v153 offset:18432
    s_waitcnt lgkmcnt(8)
    ds_read_b64_tr_b16 a[46:47], v153 offset:18944
    ds_read_b128 v[56:59], v146 offset:34816
    buffer_load_dwordx4 a[168:171], v1, s[28:31], s78 offen offset:2048 sc1
    v_add_f32 v32, v32, v48
    v_add_f32 v33, v33, v49
    v_mfma_f32_32x32x16_bf16 v[160:175], a[16:19], a[136:139], v[160:175]
    ds_read_b64_tr_b16 a[40:41], v152 offset:18432
    ds_read_b64_tr_b16 a[42:43], v152 offset:18944
    ds_read_b128 v[72:75], v149 offset:51200
    buffer_load_dwordx4 a[172:175], v1, s[28:31], s78 offen offset:3072 sc1
    s_add_u32 s78, s78, 4096
    v_add_f32 v34, v34, v50
    s_waitcnt vmcnt(9)
    v_mfma_f32_32x32x16_bf16 v[176:191], a[28:31], a[140:143], v[176:191]
    ds_read_b64_tr_b16 a[52:53], v153 offset:49152
    ds_read_b64_tr_b16 a[54:55], v153 offset:49664
    s_waitcnt lgkmcnt(8)
    ds_read_b128 v[92:95], v148 offset:3072
    v_add_f32 v35, v35, v51
    v_add_f32 v32, v32, v64
    v_add_f32 v33, v33, v65
    v_mfma_f32_32x32x16_bf16 v[160:175], a[24:27], a[140:143], v[160:175]
    ds_read_b64_tr_b16 a[48:49], v152 offset:49152
    ds_read_b64_tr_b16 a[50:51], v152 offset:49664
    ds_read_b128 v[60:63], v146 offset:35840
    buffer_load_dwordx4 a[176:179], v1, s[28:31], s78 offen offset:0 sc1
    v_add_f32 v34, v34, v66
    v_add_f32 v35, v35, v67
    s_waitcnt vmcnt(8)
    v_mfma_f32_32x32x16_bf16 v[176:191], a[36:39], a[144:147], v[176:191]
    ds_read_b64_tr_b16 a[60:61], v153 offset:51200
    ds_read_b64_tr_b16 a[62:63], v153 offset:51712
    ds_read_b128 v[76:79], v149 offset:52224
    buffer_load_dwordx4 a[180:183], v1, s[28:31], s78 offen offset:1024 sc1
    v_mul_f32 v112, v154, v32
    v_mul_f32 v113, v154, v33
    v_mfma_f32_32x32x16_bf16 v[160:175], a[32:35], a[144:147], v[160:175]
    s_waitcnt lgkmcnt(8)
    ds_read_b64_tr_b16 a[56:57], v152 offset:51200
    ds_read_b64_tr_b16 a[58:59], v152 offset:51712
    buffer_load_dwordx4 a[184:187], v1, s[28:31], s78 offen offset:2048 sc1
    v_mul_f32 v114, v154, v34
    v_mul_f32 v115, v154, v35
    s_waitcnt vmcnt(9)
    v_mfma_f32_32x32x16_bf16 v[176:191], a[44:47], a[148:151], v[176:191]
    ds_read_b64_tr_b16 a[68:69], v151 offset:8192
    ds_read_b64_tr_b16 a[70:71], v151 offset:8704
    buffer_load_dwordx4 a[188:191], v1, s[28:31], s78 offen offset:3072 sc1
    v_exp_f32 v112, v112
    v_mfma_f32_32x32x16_bf16 v[160:175], a[40:43], a[148:151], v[160:175]
    ds_read_b64_tr_b16 a[64:65], v150 offset:8192
    ds_read_b64_tr_b16 a[66:67], v150 offset:8704
    v_exp_f32 v113, v113
    v_exp_f32 v114, v114
    s_waitcnt vmcnt(9) lgkmcnt(13)
    v_mfma_f32_32x32x16_bf16 v[176:191], a[52:55], a[152:155], v[176:191]
    ds_read_b64_tr_b16 a[76:77], v151 offset:10240
    ds_read_b64_tr_b16 a[78:79], v151 offset:10752
    v_exp_f32 v115, v115
    v_fma_f32 v112, v112, v156, v156
    v_fma_f32 v113, v113, v156, v156
    s_waitcnt lgkmcnt(12)
    v_mfma_f32_32x32x16_bf16 v[160:175], a[48:51], a[152:155], v[160:175]
    ds_read_b64_tr_b16 a[72:73], v150 offset:10240
    ds_read_b64_tr_b16 a[74:75], v150 offset:10752
    v_fma_f32 v114, v114, v156, v156
    v_fma_f32 v115, v115, v156, v156
    v_rcp_f32 v112, v112
    s_waitcnt vmcnt(8) lgkmcnt(11)
    v_mfma_f32_32x32x16_bf16 v[176:191], a[60:63], a[156:159], v[176:191]
    ds_read_b64_tr_b16 a[84:85], v151 offset:12288
    ds_read_b64_tr_b16 a[86:87], v151 offset:12800
    v_rcp_f32 v113, v113
    v_rcp_f32 v114, v114
    s_waitcnt lgkmcnt(10)
    v_mfma_f32_32x32x16_bf16 v[160:175], a[56:59], a[156:159], v[160:175]
    ds_read_b64_tr_b16 a[80:81], v150 offset:12288
    ds_read_b64_tr_b16 a[82:83], v150 offset:12800
    v_rcp_f32 v115, v115
    v_mul_f32 v32, v32, v112
    v_mul_f32 v33, v33, v113
    s_waitcnt vmcnt(7) lgkmcnt(10)
    v_mfma_f32_32x32x16_bf16 v[176:191], a[68:71], a[160:163], v[176:191]
    ds_read_b64_tr_b16 a[92:93], v151 offset:14336
    ds_read_b64_tr_b16 a[94:95], v151 offset:14848
    v_mul_f32 v34, v34, v114
    v_mul_f32 v35, v35, v115
    v_add_f32 v36, v36, v84
    v_add_f32 v37, v37, v85
    s_waitcnt lgkmcnt(10)
    v_mfma_f32_32x32x16_bf16 v[160:175], a[64:67], a[160:163], v[160:175]
    ds_read_b64_tr_b16 a[88:89], v150 offset:14336
    ds_read_b64_tr_b16 a[90:91], v150 offset:14848
    v_add_f32 v38, v38, v86
    v_add_f32 v39, v39, v87
    v_add_f32 v36, v36, v52
    v_add_f32 v37, v37, v53
    s_waitcnt vmcnt(6) lgkmcnt(10)
    v_mfma_f32_32x32x16_bf16 v[176:191], a[76:79], a[164:167], v[176:191]
    ds_read_b64_tr_b16 a[100:101], v153 offset:20480
    ds_read_b64_tr_b16 a[102:103], v153 offset:20992
    v_add_f32 v38, v38, v54
    v_add_f32 v39, v39, v55
    v_add_f32 v36, v36, v68
    v_add_f32 v37, v37, v69
    s_waitcnt lgkmcnt(10)
    v_mfma_f32_32x32x16_bf16 v[160:175], a[72:75], a[164:167], v[160:175]
    ds_read_b64_tr_b16 a[108:109], v153 offset:22528
    ds_read_b64_tr_b16 a[110:111], v153 offset:23040
    v_add_f32 v38, v38, v70
    v_add_f32 v39, v39, v71
    v_mul_f32 v116, v154, v36
    v_mul_f32 v117, v154, v37
    s_waitcnt vmcnt(5) lgkmcnt(10)
    v_mfma_f32_32x32x16_bf16 v[176:191], a[84:87], a[168:171], v[176:191]
    ds_read_b64_tr_b16 a[116:117], v153 offset:53248
    ds_read_b64_tr_b16 a[118:119], v153 offset:53760
    v_mul_f32 v118, v154, v38
    v_mul_f32 v119, v154, v39
    v_exp_f32 v116, v116
    s_waitcnt lgkmcnt(10)
    v_mfma_f32_32x32x16_bf16 v[160:175], a[80:83], a[168:171], v[160:175]
    ds_read_b64_tr_b16 a[124:125], v153 offset:55296
    ds_read_b64_tr_b16 a[126:127], v153 offset:55808
    v_exp_f32 v117, v117
    v_exp_f32 v118, v118
    s_waitcnt vmcnt(4) lgkmcnt(10)
    v_mfma_f32_32x32x16_bf16 v[176:191], a[92:95], a[172:175], v[176:191]
    ds_read_b64_tr_b16 a[96:97], v152 offset:20480
    ds_read_b64_tr_b16 a[98:99], v152 offset:20992
    v_exp_f32 v119, v119
    v_fma_f32 v116, v116, v156, v156
    v_fma_f32 v117, v117, v156, v156
    s_waitcnt lgkmcnt(10)
    v_mfma_f32_32x32x16_bf16 v[160:175], a[88:91], a[172:175], v[160:175]
    ds_read_b64_tr_b16 a[104:105], v152 offset:22528
    ds_read_b64_tr_b16 a[106:107], v152 offset:23040
    v_fma_f32 v118, v118, v156, v156
    v_fma_f32 v119, v119, v156, v156
    v_rcp_f32 v116, v116
    s_waitcnt vmcnt(3) lgkmcnt(10)
    v_mfma_f32_32x32x16_bf16 v[176:191], a[100:103], a[176:179], v[176:191]
    ds_read_b64_tr_b16 a[112:113], v152 offset:53248
    ds_read_b64_tr_b16 a[114:115], v152 offset:53760
    v_rcp_f32 v117, v117
    v_rcp_f32 v118, v118
    s_waitcnt vmcnt(2) lgkmcnt(10)
    v_mfma_f32_32x32x16_bf16 v[176:191], a[108:111], a[180:183], v[176:191]
    ds_read_b64_tr_b16 a[120:121], v152 offset:55296
    ds_read_b64_tr_b16 a[122:123], v152 offset:55808
    v_rcp_f32 v119, v119
    v_mul_f32 v36, v36, v116
    v_mul_f32 v37, v37, v117
    s_waitcnt vmcnt(1) lgkmcnt(10)
    v_mfma_f32_32x32x16_bf16 v[176:191], a[116:119], a[184:187], v[176:191]
    v_mul_f32 v38, v38, v118
    v_mul_f32 v39, v39, v119
    v_add_f32 v40, v40, v88
    v_add_f32 v41, v41, v89
    v_add_f32 v42, v42, v90
    v_add_f32 v43, v43, v91
    s_waitcnt vmcnt(0) lgkmcnt(8)
    v_mfma_f32_32x32x16_bf16 v[176:191], a[124:127], a[188:191], v[176:191]
    v_add_f32 v40, v40, v56
    v_add_f32 v41, v41, v57
    v_add_f32 v42, v42, v58
    v_add_f32 v43, v43, v59
    v_add_f32 v40, v40, v72
    v_add_f32 v41, v41, v73
    s_waitcnt lgkmcnt(6)
    v_mfma_f32_32x32x16_bf16 v[160:175], a[96:99], a[176:179], v[160:175]
    v_add_f32 v42, v42, v74
    v_add_f32 v43, v43, v75
    v_mul_f32 v120, v154, v40
    v_mul_f32 v121, v154, v41
    v_mul_f32 v122, v154, v42
    v_mul_f32 v123, v154, v43
    s_waitcnt lgkmcnt(4)
    v_mfma_f32_32x32x16_bf16 v[160:175], a[104:107], a[180:183], v[160:175]
    v_exp_f32 v120, v120
    v_exp_f32 v121, v121
    v_exp_f32 v122, v122
    s_waitcnt lgkmcnt(2)
    v_mfma_f32_32x32x16_bf16 v[160:175], a[112:115], a[184:187], v[160:175]
    ds_write_b128 v144, v[176:179] offset:32768
    v_exp_f32 v123, v123
    v_fma_f32 v120, v120, v156, v156
    v_fma_f32 v121, v121, v156, v156
    v_fma_f32 v122, v122, v156, v156
    s_waitcnt lgkmcnt(1)
    v_mfma_f32_32x32x16_bf16 v[160:175], a[120:123], a[188:191], v[160:175]
    ds_write_b128 v144, v[180:183] offset:33792
    v_fma_f32 v123, v123, v156, v156
    v_rcp_f32 v120, v120
    v_rcp_f32 v121, v121
    v_rcp_f32 v122, v122
    v_rcp_f32 v123, v123
    v_mul_f32 v40, v40, v120
    v_mul_f32 v41, v41, v121
    v_mul_f32 v42, v42, v122
    v_mul_f32 v43, v43, v123
    v_add_f32 v44, v44, v92
    v_add_f32 v45, v45, v93
    v_add_f32 v46, v46, v94
    v_add_f32 v47, v47, v95
    v_add_f32 v44, v44, v60
    v_add_f32 v45, v45, v61
    v_add_f32 v46, v46, v62
    v_add_f32 v47, v47, v63
    v_add_f32 v44, v44, v76
    v_add_f32 v45, v45, v77
    v_add_f32 v46, v46, v78
    v_add_f32 v47, v47, v79
    v_mul_f32 v124, v154, v44
    v_mul_f32 v125, v154, v45
    v_mul_f32 v126, v154, v46
    v_mul_f32 v127, v154, v47
    v_exp_f32 v124, v124
    v_exp_f32 v125, v125
    v_exp_f32 v126, v126
    v_exp_f32 v127, v127
    v_fma_f32 v124, v124, v156, v156
    v_fma_f32 v125, v125, v156, v156
    v_fma_f32 v126, v126, v156, v156
    v_fma_f32 v127, v127, v156, v156
    v_rcp_f32 v124, v124
    v_rcp_f32 v125, v125
    v_rcp_f32 v126, v126
    v_rcp_f32 v127, v127
    v_mul_f32 v44, v44, v124
    v_mul_f32 v45, v45, v125
    v_mul_f32 v46, v46, v126
    v_mul_f32 v47, v47, v127
    ds_write_b128 v144, v[184:187] offset:34816
    ds_write_b128 v144, v[188:191] offset:35840
    v_pk_fma_f32 v[128:129], v[160:161], v[32:33], v[128:129]
    v_pk_fma_f32 v[130:131], v[162:163], v[34:35], v[130:131]
    v_pk_fma_f32 v[132:133], v[164:165], v[36:37], v[132:133]
    v_pk_fma_f32 v[134:135], v[166:167], v[38:39], v[134:135]
    v_pk_fma_f32 v[136:137], v[168:169], v[40:41], v[136:137]
    v_pk_fma_f32 v[138:139], v[170:171], v[42:43], v[138:139]
    v_pk_fma_f32 v[140:141], v[172:173], v[44:45], v[140:141]
    v_pk_fma_f32 v[142:143], v[174:175], v[46:47], v[142:143]
    s_waitcnt lgkmcnt(0)
    s_barrier
    ds_read_b128 v[176:179], v147 offset:32768
    ds_read_b128 v[180:183], v147 offset:33792
    ds_read_b128 v[184:187], v147 offset:34816
    ds_read_b128 v[188:191], v147 offset:35840
    s_waitcnt lgkmcnt(3)
    v_pk_fma_f32 v[128:129], v[176:177], v[32:33], v[128:129]
    v_pk_fma_f32 v[130:131], v[178:179], v[34:35], v[130:131]
    s_waitcnt lgkmcnt(2)
    v_pk_fma_f32 v[132:133], v[180:181], v[36:37], v[132:133]
    v_pk_fma_f32 v[134:135], v[182:183], v[38:39], v[134:135]
    v_cvt_pk_bf16_f32 v2, v128, v129
    v_cvt_pk_bf16_f32 v3, v130, v131
    v_cvt_pk_bf16_f32 v4, v132, v133
    v_cvt_pk_bf16_f32 v5, v134, v135
    s_nop 0
    v_permlane32_swap_b32 v2, v4
    v_permlane32_swap_b32 v3, v5
    s_waitcnt lgkmcnt(1)
    v_pk_fma_f32 v[136:137], v[184:185], v[40:41], v[136:137]
    v_pk_fma_f32 v[138:139], v[186:187], v[42:43], v[138:139]
    s_waitcnt lgkmcnt(0)
    v_pk_fma_f32 v[140:141], v[188:189], v[44:45], v[140:141]
    v_pk_fma_f32 v[142:143], v[190:191], v[46:47], v[142:143]
    v_cvt_pk_bf16_f32 v6, v136, v137
    v_cvt_pk_bf16_f32 v7, v138, v139
    v_cvt_pk_bf16_f32 v8, v140, v141
    v_cvt_pk_bf16_f32 v9, v142, v143
    s_nop 0
    v_permlane32_swap_b32 v6, v8
    v_permlane32_swap_b32 v7, v9
    s_add_u32 s62, s63, 16384
    v_permlane16_swap_b32 v2, v6
    v_permlane16_swap_b32 v3, v7
    v_permlane16_swap_b32 v4, v8
    v_permlane16_swap_b32 v5, v9
    buffer_store_dwordx4 v[2:5], v12, s[40:43], s63 offen sc0 sc1 nt
    buffer_store_dwordx4 v[6:9], v12, s[40:43], s62 offen sc0 sc1 nt
L_end:
    s_endpgm
L_stat_retry:
    s_sub_u32 s81, s81, 1
    s_cmp_le_i32 s81, 0
    s_cbranch_scc1 L_stat_ok
    v_lshrrev_b32 v8, 5, v0
    v_and_b32 v9, 0xf0, v1
    v_lshl_add_u32 v9, v8, 8, v9
    buffer_load_dwordx4 v[56:59], v9, s[28:31], s66 offen offset:0 sc1
    buffer_load_dwordx4 v[60:63], v9, s[28:31], s66 offen offset:512 sc1
    s_waitcnt vmcnt(0)
    s_branch L_stat_check
L_qa_retry:
    s_sub_u32 s81, s81, 1
    s_cmp_le_i32 s81, 0
    s_cbranch_scc1 L_qa_ok
    buffer_load_dwordx2 v[190:191], v22, s[28:31], 0 offen sc1
    s_waitcnt vmcnt(0)
    s_branch L_qa_chk
L_qb_retry:
    s_sub_u32 s81, s81, 1
    s_cmp_le_i32 s81, 0
    s_cbranch_scc1 L_qb_ok
    buffer_load_dwordx2 v[190:191], v22, s[28:31], 0 offen sc1
    s_waitcnt vmcnt(0)
    s_branch L_qb_chk
L_h_retry:
    s_sub_u32 s81, s81, 1
    s_cmp_le_i32 s81, 0
    s_cbranch_scc1 L_h_ok
    buffer_load_dwordx2 v[190:191], v23, s[28:31], 0 offen sc1
    s_waitcnt vmcnt(0)
    s_branch L_h_chk
L_at_m:
    v_mov_b64 v[178:179], v[238:239]
    s_cmp_eq_u32 s57, 2
    s_cbranch_scc1 L_at_m2_back
    s_cmp_eq_u32 s57, 4
    s_cbranch_scc1 L_at_m4_back
    s_cmp_eq_u32 s57, 6
    s_cbranch_scc1 L_at_m6_back
    s_branch L_at_m8_back
L_at_n:
    v_mov_b32 v64, 0xff800000
    v_mov_b32 v65, 0xff800000
    v_mov_b64 v[66:67], v[64:65]
    v_mov_b64 v[68:69], v[64:65]
    v_mov_b64 v[70:71], v[64:65]
    v_mov_b64 v[72:73], v[64:65]
    v_mov_b64 v[74:75], v[64:65]
    v_mov_b64 v[76:77], v[64:65]
    v_mov_b64 v[78:79], v[64:65]
    v_mov_b64 v[80:81], v[64:65]
    v_mov_b64 v[82:83], v[64:65]
    v_mov_b64 v[84:85], v[64:65]
    v_mov_b64 v[86:87], v[64:65]
    v_mov_b64 v[88:89], v[64:65]
    v_mov_b64 v[90:91], v[64:65]
    v_mov_b64 v[92:93], v[64:65]
    v_mov_b64 v[94:95], v[64:65]
    s_cmp_eq_u32 s57, 8
    s_cbranch_scc1 L_at_n7_back
    s_cmp_eq_u32 s57, 6
    s_cbranch_scc1 L_at_n5_back
    s_cmp_eq_u32 s57, 4
    s_cbranch_scc1 L_at_n3_back
    s_branch L_at_n1_back
L_o_retry:
    buffer_load_dwordx2 v[190:191], v24, s[28:31], 0 offen sc1
    s_waitcnt vmcnt(1)
    v_cmp_ne_u64 s[46:47], s[60:61], v[186:187]
    s_cmp_eq_u64 s[46:47], 0
    s_cbranch_scc1 L_o_ok
L_o_again:
    s_sub_u32 s81, s81, 1
    s_cmp_le_i32 s81, 0
    s_cbranch_scc1 L_o_ok
    buffer_load_dwordx2 v[186:187], v24, s[28:31], 0 offen sc1
    s_waitcnt vmcnt(1)
    v_cmp_ne_u64 s[46:47], s[60:61], v[190:191]
    s_cmp_eq_u64 s[46:47], 0
    s_cbranch_scc1 L_o_ok
    buffer_load_dwordx2 v[190:191], v24, s[28:31], 0 offen sc1
    s_waitcnt vmcnt(1)
    v_cmp_ne_u64 s[46:47], s[60:61], v[186:187]
    s_cmp_eq_u64 s[46:47], 0
    s_cbranch_scc1 L_o_ok
    s_branch L_o_again
L_bump:
    s_cmp_eq_u64 s[84:85], 0
    s_cbranch_scc1 L_bump_back
    s_sub_u32 s81, s81, 1
    s_cmp_le_i32 s81, 0
    s_cbranch_scc1 L_bump_back
    buffer_load_dwordx2 v[28:29], v26, s[28:31], 0 offen sc1
    s_waitcnt vmcnt(0)
    v_cmp_ne_u64 s[84:85], s[60:61], v[28:29]
    s_branch L_bump
L_last:
.section .rodata,"a"
.p2align 6
.amdhsa_kernel recurrent_scan__sliding_block__glu_gated_bilinear__prompt_kernel
  .amdhsa_next_free_vgpr 512
  .amdhsa_next_free_sgpr 102
  .amdhsa_accum_offset 256
  .amdhsa_group_segment_fixed_size 0
  .amdhsa_kernarg_size 80
  .amdhsa_user_sgpr_count 2
  .amdhsa_user_sgpr_kernarg_segment_ptr 1
  .amdhsa_system_sgpr_workgroup_id_x 1
  .amdhsa_float_denorm_mode_32 3
.end_amdhsa_kernel
```
